```python
import torch

def _softmax(x, axis=-1):
    return torch.softmax(x, dim=axis)

def _gelu(x):
    return torch.nn.functional.gelu(x, approximate='tanh')

def _silu(x):
    return torch.nn.functional.silu(x)

def _sigmoid(x):
    return torch.sigmoid(x)

def _layernorm(x, axis=-1, eps=1e-05):
    m = x.mean(dim=axis, keepdim=True)
    v = x.var(dim=axis, keepdim=True, unbiased=False)
    return (x - m) / torch.sqrt(v + eps)

def _scatter_add(tgt, idx, src, axis=0):
    return tgt.clone().index_add_(axis, idx, src)

def _segment_sum(src, seg, n):
    out = torch.zeros((n,) + src.shape[1:], dtype=src.dtype)
    return out.index_add_(0, seg, src)

def _pad(x, pw):
    flat = tuple((v for pair in reversed(pw) for v in pair))
    return torch.nn.functional.pad(x, flat)
kernel_name = 'gated_mix__spectral_fnet__mixer_gmlp__prompt'

def setup_inputs():

    _w = lambda a: (lambda t: t.to(torch.bfloat16) if t.is_floating_point() else t)(torch.as_tensor(a))

    def _A_setup():
        B, S, D = (1, 2048, 640)
        ns = torch.arange(S)[:, None] * torch.arange(S)[None, :]
        nd = torch.arange(D)[:, None] * torch.arange(D)[None, :]
        Ws_re = torch.cos(-2.0 * torch.pi * ns / S).to(float)
        Ws_im = torch.sin(-2.0 * torch.pi * ns / S).to(float)
        Wd_re = torch.cos(-2.0 * torch.pi * nd / D).to(float)
        Wd_im = torch.sin(-2.0 * torch.pi * nd / D).to(float)
        return {'x': _w((lambda *s: torch.randn(*s, dtype=torch.bfloat16) * 0.05)(B, S, D)), 'dft_seq_re': _w(Ws_re), 'dft_seq_im': _w(Ws_im), 'dft_hid_re': _w(Wd_re), 'dft_hid_im': _w(Wd_im)}
    _A_in = _A_setup()

    def _B_setup():
        B, S, D, F = (1, 2048, 640, 1536)
        Fh = F // 2
        return {'x': _w((lambda *s: torch.randn(*s, dtype=torch.bfloat16) * 0.05)(B, S, D)), 'w_in': _w((lambda *s: torch.randn(*s, dtype=torch.bfloat16) * 0.8)(D, 2 * Fh)), 'w_sp': _w(0.01 * (lambda *s: torch.randn(*s, dtype=torch.bfloat16) * 0.8)(S, S)), 'b_sp': _w(1.0 + 0.01 * (lambda *s: torch.randn(*s, dtype=torch.bfloat16) * 0.8)(S)), 'w_out': _w((lambda *s: torch.randn(*s, dtype=torch.bfloat16) * 0.8)(Fh, D))}
    _B_in = _B_setup()
    return {'A_x': _A_in['x'], 'A_dft_seq_re': _A_in['dft_seq_re'], 'A_dft_seq_im': _A_in['dft_seq_im'], 'A_dft_hid_re': _A_in['dft_hid_re'], 'A_dft_hid_im': _A_in['dft_hid_im'], 'B_x': _B_in['x'], 'B_w_in': _B_in['w_in'], 'B_w_sp': _B_in['w_sp'], 'B_b_sp': _B_in['b_sp'], 'B_w_out': _B_in['w_out'], 'gate_w': _w((lambda *s: torch.randn(*s, dtype=torch.bfloat16) * 0.05)(640) * 16.0)}

def reference(A_x, A_dft_seq_re, A_dft_seq_im, A_dft_hid_re, A_dft_hid_im, B_x, B_w_in, B_w_sp, B_b_sp, B_w_out, gate_w):

    def _A_ref(x, dft_seq_re, dft_seq_im, dft_hid_re, dft_hid_im):
        a = torch.einsum('bsd,ed->bse', x, dft_hid_re)
        b = torch.einsum('bsd,ed->bse', x, dft_hid_im)
        y = torch.einsum('ts,bse->bte', dft_seq_re, a) - torch.einsum('ts,bse->bte', dft_seq_im, b)
        return y

    def _B_ref(x, w_in, w_sp, b_sp, w_out):
        B, S, D = x.shape
        F = w_in.shape[-1]
        Fh = F // 2
        z = _gelu(torch.einsum('bsd,df->bsf', x, w_in))
        z1 = z[..., :Fh].clone()
        z2 = _layernorm(z[..., Fh:], axis=-1)
        g = torch.einsum('ts,bsf->btf', w_sp, z2) + b_sp[None, :, None]
        return torch.einsum('bsf,fd->bsd', z1 * g, w_out)
    x = A_x
    g = _sigmoid((x * gate_w).sum(-1, keepdims=True))
    a = _A_ref(x, A_dft_seq_re, A_dft_seq_im, A_dft_hid_re, A_dft_hid_im)
    b = _B_ref(x, B_w_in, B_w_sp, B_b_sp, B_w_out)
    return g * a + (1 - g) * b
```

```asm
; @launch grid=(256,1,1) block=(256,1,1) lds=163840
.amdgcn_target "amdgcn-amd-amdhsa--gfx950"
.text
.globl gated_mix__spectral_fnet__mixer_gmlp__prompt_kernel
.p2align 8
.type gated_mix__spectral_fnet__mixer_gmlp__prompt_kernel,@function
gated_mix__spectral_fnet__mixer_gmlp__prompt_kernel:
    s_cmp_ge_u32 s2, 256
    s_cbranch_scc1 L_end
    s_load_dwordx2 s[4:5], s[0:1], 0
    s_load_dwordx16 s[48:63], s[0:1], 48
    s_load_dwordx4 s[44:47], s[0:1], 24
    s_getpc_b64 s[40:41]
L_pc:
    s_mov_b32 s42, CODE_BYTES
    s_mov_b32 s43, 0x20000
    v_lshrrev_b32 v50, 3, v0
    v_lshlrev_b32 v50, 7, v50
    buffer_load_dword v48, v50, s[40:43], 0 offen offset:256
    v_lshrrev_b32 v2, 6, v0
    v_and_b32 v1, 63, v0
    v_readfirstlane_b32 s64, v2
    s_bfe_u32 s65, s2, 0x20001
    s_lshl_b32 s65, s65, 3
    s_bfe_u32 s95, s2, 0x30003
    s_add_u32 s65, s65, s95
    s_lshr_b32 s96, s2, 6
    s_and_b32 s67, s64, 1
    s_lshr_b32 s94, s64, 1
    v_lshrrev_b32 v251, 4, v1
    v_and_b32 v40, 7, v1
    v_xor_b32 v40, v40, v251
    v_lshlrev_b32 v40, 4, v40
    v_lshrrev_b32 v41, 3, v1
    s_mov_b32 s78, 81920
    v_mad_u32_u24 v2, v41, s78, v40
    v_xor_b32 v3, 64, v2
    v_add_u32 v3, 654336, v3
    s_lshr_b32 s79, s96, 0
    s_mul_i32 s79, s79, 2
    s_add_u32 s95, s95, s79
    s_mul_i32 s79, s95, 52
    s_lshr_b32 s79, s79, 8
    s_mul_i32 s79, s79, 5
    s_sub_u32 s95, s95, s79
    s_lshl_b32 s70, s95, 7
    s_mul_i32 s78, s65, 1280
    s_mul_i32 s79, s94, 1310720
    s_add_u32 s78, s78, s79
    s_mul_i32 s79, s67, 41600
    s_add_u32 s84, s78, s79
    s_mul_i32 s79, s67, 40320
    s_sub_u32 s78, s78, s79
    s_add_u32 s85, s78, 40960
    s_lshl_b32 s80, s64, 12
    s_add_u32 s80, s80, 73728
    s_mov_b32 s6, 2621440
    s_mov_b32 s7, 0x20000
    v_lshl_add_u32 v10, v41, 18, v40
    s_and_b32 s66, s2, 1
    s_lshl_b32 s66, s66, 2
    s_add_u32 s66, s66, s96
    s_waitcnt lgkmcnt(0)
    s_add_u32 m0, s80, 0
    s_add_u32 s77, s84, s70
    buffer_load_dwordx4 v2, s[4:7], s77 offen lds
    buffer_load_dwordx4 v3, s[4:7], s77 offen offset:1024 lds
    s_add_u32 m0, s80, 2048
    s_add_u32 s77, s85, s70
    buffer_load_dwordx4 v2, s[4:7], s77 offen lds
    buffer_load_dwordx4 v3, s[4:7], s77 offen offset:1024 lds
    v_lshrrev_b32 v51, 5, v0
    v_lshlrev_b32 v51, 7, v51
    s_lshr_b32 s78, s2, 3
    s_lshl_b32 s78, s78, 10
    s_add_u32 s78, s78, 4352
    buffer_load_dword v49, v51, s[40:43], s78 offen
    v_lshlrev_b32 v12, 4, v1
    v_mul_u32_u24 v40, 5462, v1
    s_movk_i32 s78, 2880
    v_add_u32 v41, 349568, v40
    v_add_u32 v42, 699136, v40
    v_lshrrev_b32 v40, 16, v40
    v_mad_u32_u24 v4, v40, s78, v12
    v_lshrrev_b32 v41, 16, v41
    v_mad_u32_u24 v5, v41, s78, v12
    v_lshrrev_b32 v42, 16, v42
    v_mad_u32_u24 v6, v42, s78, v12
    v_and_b32 v40, 32, v1
    v_xor_b32 v5, v5, v40
    v_xor_b32 v6, 32, v6
    s_mul_i32 s78, s67, 983040
    s_mul_i32 s79, s94, 98304
    s_add_u32 s78, s78, s79
    s_mul_i32 s79, s66, 192
    s_add_u32 s76, s78, s79
    s_add_u32 s75, s76, 1536
    s_mul_i32 s78, s67, 12288
    s_mul_i32 s79, s94, 6144
    s_add_u32 s81, s78, s79
    s_mov_b64 s[8:9], s[48:49]
    s_mov_b32 s10, 1966080
    s_mov_b32 s11, 0x20000
    s_add_u32 s71, s70, 128
    s_cmp_ge_u32 s71, 640
    s_cselect_b32 s71, 0, s71
    s_add_u32 s72, s71, 128
    s_cmp_ge_u32 s72, 640
    s_cselect_b32 s72, 0, s72
    s_add_u32 s73, s72, 128
    s_cmp_ge_u32 s73, 640
    s_cselect_b32 s73, 0, s73
    s_add_u32 s74, s73, 128
    s_cmp_ge_u32 s74, 640
    s_cselect_b32 s74, 0, s74
    v_and_b32 v252, 15, v1
    s_mov_b64 s[12:13], s[50:51]
    s_mov_b32 s14, 8388608
    s_mov_b32 s15, 0x20000
    v_xor_b32 v11, 64, v10
    v_add_u32 v11, 2096128, v11
    s_mul_i32 s82, s64, 3072
    s_mul_i32 s83, s64, 12288
    s_add_u32 s83, s83, 81920
    s_lshl_b32 s100, s64, 10
    s_mul_i32 s77, s70, 1536
    s_add_u32 m0, s81, 0
    s_add_u32 s77, s77, s75
    buffer_load_dwordx4 v4, s[8:11], s77 offen offset:0 lds
    s_mov_b64 s[36:37], s[52:53]
    buffer_load_dwordx4 v5, s[8:11], s77 offen offset:1024 lds
    s_mov_b32 s38, 4096
    s_mov_b32 s39, 0x20000
    s_mov_b64 s[28:29], s[54:55]
    s_mov_b32 s30, 983040
    s_mov_b32 s31, 0x20000
    s_mov_b64 s[32:33], s[56:57]
    s_mov_b32 s34, 1280
    s_mov_b32 s35, 0x20000
    s_mov_b64 s[24:25], s[58:59]
    s_mov_b32 s26, 2621440
    s_mov_b32 s27, 0x20000
    s_mov_b64 s[20:21], s[62:63]
    s_mov_b32 s22, 33554432
    s_mov_b32 s23, 0x20000
    s_cmp_eq_u32 s94, 0
    s_cselect_b64 s[16:17], s[44:45], s[46:47]
    s_mov_b32 s18, 819200
    s_mov_b32 s19, 0x20000
    v_mov_b32 v43, 0
    buffer_load_dword v31, v43, s[20:23], 0 offen sc1
    s_lshl_b32 s78, s94, 5
    s_add_u32 s78, s78, s67
    s_lshl_b32 s78, s78, 5
    s_add_u32 s78, s78, s65
    s_lshl_b32 s78, s78, 1
    v_lshlrev_b32 v42, 7, v252
    buffer_load_ushort v28, v42, s[36:39], s78 offen
    s_xor_b32 s78, s78, 64
    buffer_load_ushort v23, v42, s[36:39], s78 offen
    v_lshrrev_b32 v40, 1, v252
    v_xor_b32 v40, v40, v251
    v_lshlrev_b32 v40, 4, v40
    v_lshl_add_u32 v13, v252, 7, v40
    v_xor_b32 v14, 64, v13
    s_xor_b32 s78, s80, 4096
    v_add_u32 v15, s80, v13
    v_add_u32 v112, s78, v13
    v_add_u32 v17, s83, v13
    v_add_u32 v16, s80, v14
    v_add_u32 v113, s78, v14
    v_add_u32 v18, s83, v14
    v_bfe_u32 v40, v1, 2, 2
    v_lshl_add_u32 v40, v251, 3, v40
    v_mul_u32_u24 v40, 192, v40
    v_and_b32 v41, 3, v1
    v_lshl_add_u32 v40, v41, 3, v40
    v_xor_b32 v41, s67, v251
    v_and_b32 v41, 1, v41
    v_lshl_add_u32 v40, v41, 5, v40
    s_mul_i32 s78, s67, 12288
    v_add_u32 v19, s78, v40
    s_sub_u32 s78, 12288, s78
    v_add_u32 v20, s78, v40
    s_mul_i32 s78, s67, 640
    s_add_u32 s79, s78, 135168
    v_lshl_add_u32 v21, v251, 4, s79
    s_sub_u32 s79, 135808, s78
    v_lshl_add_u32 v114, v251, 4, s79
    v_and_b32 v40, 1, v251
    v_xor_b32 v40, s64, v40
    v_mul_u32_u24 v40, 24576, v40
    v_lshrrev_b32 v41, 1, v251
    v_lshl_add_u32 v40, v41, 8, v40
    v_lshl_add_u32 v40, v252, 4, v40
    s_lshl_b32 s78, s67, 9
    v_add_u32 v255, s78, v40
    s_lshl_b32 s78, s65, 2
    s_add_u32 s78, s78, s64
    s_mul_i32 s79, s78, 205
    s_lshr_b32 s79, s79, 10
    s_mul_i32 s95, s79, 5
    s_sub_u32 s95, s78, s95
    s_and_b32 s96, s79, 7
    s_mul_i32 s96, s96, 3
    s_lshr_b32 s79, s79, 3
    s_add_u32 s79, s79, s96
    s_mul_i32 s79, s79, 40960
    s_lshl_b32 s95, s95, 5
    s_add_u32 s79, s79, s95
    s_mul_i32 s95, s66, 160
    s_add_u32 s79, s79, s95
    s_mul_i32 s95, s66, 120
    s_add_u32 s95, s95, s78
    s_lshl_b32 s95, s95, 10
    s_add_u32 s95, s95, 0x100000
    s_cmp_lt_u32 s78, 120
    s_cselect_b32 s101, s79, 0x40000000
    s_cselect_b32 s97, s95, 0x40000000
    v_lshrrev_b32 v40, 1, v1
    v_mul_u32_u24 v40, 1280, v40
    v_and_b32 v41, 1, v1
    v_lshl_add_u32 v32, v41, 4, v40
    s_mul_i32 s78, s64, 6144
    s_add_u32 s78, s78, 139264
    v_add_u32 v24, s78, v12
    s_xor_b32 s78, s64, 1
    s_mul_i32 s78, s78, 6144
    s_add_u32 s78, s78, 139264
    v_add_u32 v25, s78, v12
    s_xor_b32 s78, s64, 2
    s_mul_i32 s78, s78, 6144
    s_add_u32 s78, s78, 141312
    v_add_u32 v26, s78, v12
    s_xor_b32 s78, s64, 3
    s_mul_i32 s78, s78, 6144
    s_add_u32 s78, s78, 143360
    v_add_u32 v27, s78, v12
    s_lshl_b32 s78, s64, 9
    s_add_u32 s78, s78, 139264
    v_lshl_add_u32 v120, v1, 3, s78
    s_mul_i32 s78, s67, 24
    s_mul_i32 s79, s66, 51200
    v_lshrrev_b32 v40, 3, v1
    v_add_u32 v40, s78, v40
    v_lshrrev_b32 v41, 1, v40
    v_xor_b32 v41, v41, v1
    v_and_b32 v41, 7, v41
    v_min_u32 v40, 40, v40
    v_mul_u32_u24 v40, 1280, v40
    v_lshl_add_u32 v40, v41, 4, v40
    v_add_u32 v7, s79, v40
    v_lshrrev_b32 v40, 3, v1
    v_add_u32 v40, s78, v40
    v_add_u32 v40, 8, v40
    v_lshrrev_b32 v41, 1, v40
    v_xor_b32 v41, v41, v1
    v_and_b32 v41, 7, v41
    v_min_u32 v40, 40, v40
    v_mul_u32_u24 v40, 1280, v40
    v_lshl_add_u32 v40, v41, 4, v40
    v_add_u32 v8, s79, v40
    v_subrev_u32 v8, 1024, v8
    v_lshrrev_b32 v40, 3, v1
    v_add_u32 v40, s78, v40
    v_add_u32 v40, 16, v40
    v_lshrrev_b32 v41, 1, v40
    v_xor_b32 v41, v41, v1
    v_and_b32 v41, 7, v41
    v_cmp_lt_u32 vcc, 40, v40
    v_mov_b32 v43, 0x8000
    s_nop 0
    v_cndmask_b32 v40, v40, v43, vcc
    v_mul_u32_u24 v40, 1280, v40
    v_lshl_add_u32 v40, v41, 4, v40
    v_add_u32 v9, s79, v40
    v_subrev_u32 v9, 2048, v9
    s_mov_b32 s3, 0
    s_lshr_b32 s78, s66, 2
    s_lshl_b32 s3, s78, 3
    s_and_b32 s78, s66, 3
    s_lshl_b32 s78, s78, 1
    s_or_b32 s3, s3, s78
    s_and_b32 s78, s3, 1
    s_lshl_b32 s78, s78, 6
    v_xor_b32 v17, s78, v17
    v_xor_b32 v18, s78, v18
    s_lshr_b32 s95, s3, 1
    s_lshl_b32 s95, s95, 7
    s_lshl_b32 s78, s94, 5
    s_add_u32 s78, s78, s67
    s_lshl_b32 s78, s78, 5
    s_add_u32 s78, s78, s65
    s_lshl_b32 s78, s78, 12
    s_add_u32 s78, s78, s100
    s_or_b32 s86, s78, s95
    s_xor_b32 s87, s86, 0x20000
    s_xor_b32 s88, s86, 0x400000
    s_xor_b32 s89, s86, 0x420000
    s_bfe_u32 s61, s3, 0x20001
    s_andn2_b32 s61, s61, 0
    s_lshl_b32 s59, s61, 4
    s_lshl_b32 s61, s61, 7
    s_mul_i32 s78, s66, 12
    s_lshl_b32 s79, s94, 1
    s_add_u32 s78, s78, s79
    s_and_b32 s79, s3, 1
    s_add_u32 s78, s78, s79
    s_lshl_b32 s78, s78, 15
    s_lshl_b32 s79, s67, 14
    s_add_u32 s78, s78, s79
    s_lshr_b32 s79, s3, 3
    s_lshl_b32 s79, s79, 13
    s_add_u32 s78, s78, s79
    s_add_u32 s90, s78, 0x200000
    s_lshl_b32 s78, s65, 2
    s_add_u32 s78, s78, s64
    s_mul_i32 s78, s78, 24576
    s_add_u32 s91, s78, 0x500000
    s_mul_i32 s78, s66, 122880
    s_add_u32 s78, s78, s100
    s_add_u32 s98, s78, 0x100000
    s_lshl_b32 s78, s65, 3
    s_add_u32 s78, s78, s66
    s_mul_i32 s78, s78, 20480
    s_mul_i32 s79, s64, 5120
    s_add_u32 s78, s78, s79
    s_add_u32 s99, s78, 0x800000
    v_lshrrev_b32 v41, 1, v251
    s_lshl_b32 s78, s67, 1
    v_add_u32 v43, s78, v41
    v_and_b32 v41, 3, v1
    v_lshl_or_b32 v40, v43, 2, v41
    s_and_b32 s78, s65, 11
    v_xor_b32 v40, s78, v40
    v_lshlrev_b32 v40, 4, v40
    v_lshrrev_b32 v41, 2, v252
    v_lshl_add_u32 v40, v41, 13, v40
    v_and_b32 v41, 1, v251
    v_xor_b32 v41, s64, v41
    v_lshl_add_u32 v40, v41, 15, v40
    s_lshl_b32 s78, s65, 8
    v_add_u32 v30, s78, v40
    s_mov_b32 s92, 0xbdd2d3e8
    s_mov_b32 s93, s92
    v_mov_b32 v248, 0xc0135761
    v_mov_b32 v249, v248
    s_mov_b32 s69, 200000
    v_and_b32 v40, 1, v252
    v_lshlrev_b32 v40, 31, v40
    v_or_b32 v40, 1.0, v40
    s_cmp_eq_u32 s67, 0
    s_cselect_b64 vcc, -1, 0
    v_cndmask_b32 v253, v40, 1.0, vcc
    v_cndmask_b32 v254, 1.0, v40, vcc
    v_sub_u32 v40, 16, v252
    v_lshrrev_b32 v41, 1, v40
    v_xor_b32 v41, v41, v251
    v_and_b32 v41, 7, v41
    v_lshlrev_b32 v41, 4, v41
    v_lshl_add_u32 v36, v40, 7, v41
    v_xor_b32 v37, 64, v36
    v_add_u32 v40, 32, v252
    v_sub_u32 v42, 48, v252
    v_cmp_gt_u32 vcc, 8, v252
    v_mov_b32 v41, 0x80008000
    s_nop 0
    v_cndmask_b32 v40, v42, v40, vcc
    v_cndmask_b32 v39, v41, 0, vcc
    v_lshrrev_b32 v41, 1, v40
    v_xor_b32 v41, v41, v251
    v_and_b32 v41, 7, v41
    v_lshlrev_b32 v41, 4, v41
    v_lshl_add_u32 v34, v40, 7, v41
    v_xor_b32 v35, 64, v34
    s_mul_i32 s78, s66, 20480
    s_sub_u32 s78, 71680, s78
    s_mov_b32 s79, 81600
    v_mul_u32_u24 v40, 3277, v1
    v_lshrrev_b32 v41, 16, v40
    v_mad_u32_u24 v42, v41, s79, v12
    v_bfe_i32 v41, v40, 16, 1
    v_and_b32 v41, s78, v41
    v_add_u32 v121, v41, v42
    v_add_u32 v40, 209728, v40
    v_lshrrev_b32 v41, 16, v40
    buffer_load_dwordx4 v6, s[8:11], s77 offen offset:2048 lds
    v_mad_u32_u24 v42, v41, s79, v12
    v_bfe_i32 v41, v40, 16, 1
    v_and_b32 v41, s78, v41
    v_add_u32 v122, v41, v42
    v_add_u32 v40, 209728, v40
    v_lshrrev_b32 v41, 16, v40
    v_mad_u32_u24 v42, v41, s79, v12
    v_bfe_i32 v41, v40, 16, 1
    v_and_b32 v41, s78, v41
    v_add_u32 v123, v41, v42
    v_add_u32 v40, 209728, v40
    v_lshrrev_b32 v41, 16, v40
    v_mad_u32_u24 v42, v41, s79, v12
    v_bfe_i32 v41, v40, 16, 1
    v_and_b32 v41, s78, v41
    v_add_u32 v124, v41, v42
    v_add_u32 v40, 209728, v40
    v_lshrrev_b32 v41, 16, v40
    v_mad_u32_u24 v42, v41, s79, v12
    v_bfe_i32 v41, v40, 16, 1
    v_and_b32 v41, s78, v41
    v_add_u32 v125, v41, v42
    v_lshrrev_b32 v41, 3, v252
    v_mul_u32_u24 v41, 24, v41
    s_lshl_b32 s78, s64, 3
    v_add3_u32 v40, s78, v252, v41
    v_and_b32 v41, 1, v251
    v_lshlrev_b32 v41, 4, v41
    v_lshrrev_b32 v42, 1, v251
    v_add_u32 v41, v41, v42
    s_mul_i32 s77, s70, 1536
    s_add_u32 m0, s81, 3072
    s_add_u32 s77, s77, s75
    s_add_u32 s77, s77, 49152
    buffer_load_dwordx4 v4, s[8:11], s77 offen offset:0 lds
    v_lshlrev_b32 v41, 5, v41
    v_add_u32 v41, s65, v41
    v_mul_u32_u24 v41, v40, v41
    v_lshlrev_b32 v42, 6, v40
    v_and_b32 v250, 1, v40
    v_mul_u32_u24 v250, 0x8000, v250
    v_lshl_or_b32 v250, v250, 16, v250
    v_cvt_f32_u32 v41, v41
    v_cvt_f32_u32 v42, v42
    v_mul_f32 v64, 0x3a000000, v41
    v_mul_f32 v42, 0x3a000000, v42
    v_add_f32 v65, v64, v42
    v_add_f32 v66, v65, v42
    v_add_f32 v67, v66, v42
    v_add_f32 v68, v67, v42
    v_add_f32 v69, v68, v42
    v_add_f32 v70, v69, v42
    v_add_f32 v71, v70, v42
    v_sin_f32 v72, v64
    v_cos_f32 v64, v64
    v_sin_f32 v73, v65
    v_cos_f32 v65, v65
    v_sin_f32 v74, v66
    buffer_load_dwordx4 v5, s[8:11], s77 offen offset:1024 lds
    v_cos_f32 v66, v66
    v_sin_f32 v75, v67
    v_cos_f32 v67, v67
    v_sin_f32 v76, v68
    v_cos_f32 v68, v68
    v_sin_f32 v77, v69
    v_cos_f32 v69, v69
    v_sin_f32 v78, v70
    v_cos_f32 v70, v70
    v_sin_f32 v79, v71
    v_cos_f32 v71, v71
    v_cvt_pk_bf16_f32 v240, v64, v65
    v_cvt_pk_bf16_f32 v244, v72, v73
    v_cvt_pk_bf16_f32 v241, v66, v67
    v_cvt_pk_bf16_f32 v245, v74, v75
    v_cvt_pk_bf16_f32 v242, v68, v69
    v_cvt_pk_bf16_f32 v246, v76, v77
    v_cvt_pk_bf16_f32 v243, v70, v71
    v_cvt_pk_bf16_f32 v247, v78, v79
    s_lshl_b32 s78, s94, 4
    v_add_u32 v40, s78, v252
    v_lshrrev_b32 v41, 1, v251
    buffer_load_dwordx4 v6, s[8:11], s77 offen offset:2048 lds
    v_lshlrev_b32 v41, 3, v41
    v_mul_u32_u24 v41, v40, v41
    v_and_b32 v42, 1, v251
    v_mul_u32_u24 v42, 24, v42
    v_add_u32 v41, v41, v42
    v_cvt_f32_u32 v41, v41
    v_cvt_f32_u32 v42, v40
    v_mul_f32 v64, 0x3d000000, v41
    v_mul_f32 v42, 0x3d000000, v42
    v_add_f32 v65, v64, v42
    v_add_f32 v66, v65, v42
    v_add_f32 v67, v66, v42
    v_add_f32 v68, v67, v42
    v_add_f32 v69, v68, v42
    v_add_f32 v70, v69, v42
    v_add_f32 v71, v70, v42
    v_cos_f32 v64, v64
    v_cos_f32 v65, v65
    v_cos_f32 v66, v66
    v_cos_f32 v67, v67
    v_cos_f32 v68, v68
    v_cos_f32 v69, v69
    v_cos_f32 v70, v70
    v_cos_f32 v71, v71
    v_and_b32 v40, 1, v40
    s_mul_i32 s77, s64, 320
    s_add_u32 m0, s77, 135168
    s_mov_b64 exec, 0xfffff
    buffer_load_dwordx4 v12, s[32:35], s77 offen lds
    s_mov_b64 exec, -1
    v_mul_u32_u24 v40, 0x8000, v40
    v_lshl_or_b32 v40, v40, 16, v40
    v_cvt_pk_bf16_f32 v56, v64, v65
    v_cvt_pk_bf16_f32 v57, v66, v67
    v_cvt_pk_bf16_f32 v58, v68, v69
    v_cvt_pk_bf16_f32 v59, v70, v71
    v_xor_b32 v60, v56, v40
    v_xor_b32 v61, v57, v40
    v_xor_b32 v62, v58, v40
    v_xor_b32 v63, v59, v40
    s_waitcnt vmcnt(7)
    v_readfirstlane_b32 s68, v31
    s_nop 0
    s_mul_i32 s68, s68, 0x9e3779b1
    s_add_u32 s68, s68, 0x7f4a7c15
    v_mov_b32 v31, s68
    s_waitcnt vmcnt(6)
    v_lshlrev_b32 v28, 16, v28
    s_waitcnt vmcnt(5)
    v_lshlrev_b32 v23, 16, v23
    s_add_u32 m0, s80, 16384
    s_add_u32 s77, s84, s71
    buffer_load_dwordx4 v2, s[4:7], s77 offen lds
    buffer_load_dwordx4 v3, s[4:7], s77 offen offset:1024 lds
    s_add_u32 m0, s80, 18432
    s_add_u32 s77, s85, s71
    buffer_load_dwordx4 v2, s[4:7], s77 offen lds
    buffer_load_dwordx4 v3, s[4:7], s77 offen offset:1024 lds
    s_mul_i32 s77, s71, 1536
    s_add_u32 m0, s81, 24576
    s_add_u32 s77, s77, s75
    buffer_load_dwordx4 v4, s[8:11], s77 offen offset:0 lds
    buffer_load_dwordx4 v5, s[8:11], s77 offen offset:1024 lds
    buffer_load_dwordx4 v6, s[8:11], s77 offen offset:2048 lds
    s_waitcnt vmcnt(7)
    s_mul_i32 s77, s71, 1536
    s_add_u32 m0, s81, 27648
    s_add_u32 s77, s77, s75
    s_add_u32 s77, s77, 49152
    buffer_load_dwordx4 v4, s[8:11], s77 offen offset:0 lds
    s_barrier
    buffer_load_dwordx4 v5, s[8:11], s77 offen offset:1024 lds
    v_add_u32 v22, s70, v21
    v_add_u32 v115, s70, v114
    ds_read_b128 a[96:99], v15 offset:0
    ds_read_b128 a[100:103], v15 offset:2048
    ds_read_b64_tr_b16 v[128:129], v19 offset:0
    ds_read_b64_tr_b16 v[130:131], v19 offset:768
    ds_read_b64_tr_b16 v[132:133], v19 offset:64
    ds_read_b64_tr_b16 v[134:135], v19 offset:832
    ds_read_b64_tr_b16 v[136:137], v19 offset:128
    ds_read_b64_tr_b16 v[138:139], v19 offset:896
    buffer_load_dwordx4 v6, s[8:11], s77 offen offset:2048 lds
    ds_read_b128 v[152:155], v22 offset:0
    ds_read_b128 a[104:107], v112 offset:2048
    ds_read_b128 a[108:111], v112 offset:0
    ds_read_b64_tr_b16 v[140:141], v20 offset:0
    ds_read_b64_tr_b16 v[142:143], v20 offset:768
    ds_read_b64_tr_b16 v[144:145], v20 offset:64
    ds_read_b64_tr_b16 v[146:147], v20 offset:832
    ds_read_b64_tr_b16 v[148:149], v20 offset:128
    s_add_u32 m0, s80, 32768
    s_add_u32 s77, s84, s72
    buffer_load_dwordx4 v2, s[4:7], s77 offen lds
    ds_read_b64_tr_b16 v[150:151], v20 offset:896
    ds_read_b128 v[156:159], v115 offset:0
    s_waitcnt lgkmcnt(14)
    v_mfma_f32_16x16x32_bf16 v[192:195], v[128:131], a[96:99], 0
    ds_read_b128 a[112:115], v16 offset:0
    ds_read_b128 a[116:119], v16 offset:2048
    v_mfma_f32_16x16x32_bf16 v[196:199], v[128:131], a[100:103], 0
    ds_read_b64_tr_b16 v[160:161], v19 offset:6144
    s_waitcnt lgkmcnt(15)
    v_mfma_f32_16x16x32_bf16 v[200:203], v[132:135], a[96:99], 0
    ds_read_b64_tr_b16 v[162:163], v19 offset:6912
    ds_read_b64_tr_b16 v[164:165], v19 offset:6208
    v_mfma_f32_16x16x32_bf16 v[204:207], v[132:135], a[100:103], 0
    ds_read_b64_tr_b16 v[166:167], v19 offset:6976
    ds_read_b64_tr_b16 v[168:169], v19 offset:6272
    s_waitcnt lgkmcnt(15)
    v_mfma_f32_16x16x32_bf16 v[208:211], v[136:139], a[96:99], 0
    ds_read_b64_tr_b16 v[170:171], v19 offset:7040
    ds_read_b128 v[184:187], v22 offset:64
    v_mfma_f32_16x16x32_bf16 v[212:215], v[136:139], a[100:103], 0
    buffer_load_dwordx4 v3, s[4:7], s77 offen offset:1024 lds
    ds_read_b128 a[120:123], v113 offset:2048
    v_mfma_f32_16x16x32_bf16 v[116:119], v[152:155], a[96:99], 0
    ds_read_b128 a[124:127], v113 offset:0
    ds_read_b64_tr_b16 v[172:173], v20 offset:6144
    s_waitcnt lgkmcnt(15)
    v_mfma_f32_16x16x32_bf16 v[192:195], v[140:143], a[104:107], v[192:195]
    ds_read_b64_tr_b16 v[174:175], v20 offset:6912
    ds_read_b64_tr_b16 v[176:177], v20 offset:6208
    v_mfma_f32_16x16x32_bf16 v[196:199], v[140:143], a[108:111], v[196:199]
    ds_read_b64_tr_b16 v[178:179], v20 offset:6976
    ds_read_b64_tr_b16 v[180:181], v20 offset:6272
    v_mfma_f32_16x16x32_bf16 v[200:203], v[144:147], a[104:107], v[200:203]
    s_add_u32 m0, s80, 34816
    s_add_u32 s77, s85, s72
    buffer_load_dwordx4 v2, s[4:7], s77 offen lds
    ds_read_b64_tr_b16 v[182:183], v20 offset:7040
    v_mfma_f32_16x16x32_bf16 v[204:207], v[144:147], a[108:111], v[204:207]
    buffer_load_dwordx4 v3, s[4:7], s77 offen offset:1024 lds
    ds_read_b128 v[188:191], v115 offset:64
    s_waitcnt lgkmcnt(15)
    v_mfma_f32_16x16x32_bf16 v[208:211], v[148:151], a[104:107], v[208:211]
    v_mfma_f32_16x16x32_bf16 v[212:215], v[148:151], a[108:111], v[212:215]
    v_mfma_f32_16x16x32_bf16 v[116:119], v[156:159], a[104:107], v[116:119]
    s_mul_i32 s77, s72, 1536
    s_add_u32 m0, s81, 49152
    s_add_u32 s77, s77, s75
    buffer_load_dwordx4 v4, s[8:11], s77 offen offset:0 lds
    s_waitcnt lgkmcnt(0)
    buffer_load_dwordx4 v5, s[8:11], s77 offen offset:1024 lds
    buffer_load_dwordx4 v6, s[8:11], s77 offen offset:2048 lds
    s_mul_i32 s77, s72, 1536
    s_add_u32 m0, s81, 52224
    s_add_u32 s77, s77, s75
    s_add_u32 s77, s77, 49152
    buffer_load_dwordx4 v4, s[8:11], s77 offen offset:0 lds
    s_waitcnt vmcnt(8)
    s_barrier
    v_mfma_f32_16x16x32_bf16 v[192:195], v[160:163], a[112:115], v[192:195]
    v_add_u32 v22, s71, v21
    v_add_u32 v115, s71, v114
    v_mfma_f32_16x16x32_bf16 v[196:199], v[160:163], a[116:119], v[196:199]
    buffer_load_dwordx4 v5, s[8:11], s77 offen offset:1024 lds
    ds_read_b128 a[128:131], v15 offset:16384
    v_mfma_f32_16x16x32_bf16 v[200:203], v[164:167], a[112:115], v[200:203]
    ds_read_b128 a[132:135], v15 offset:18432
    ds_read_b64_tr_b16 v[128:129], v19 offset:24576
    v_mfma_f32_16x16x32_bf16 v[204:207], v[164:167], a[116:119], v[204:207]
    ds_read_b64_tr_b16 v[130:131], v19 offset:25344
    ds_read_b64_tr_b16 v[132:133], v19 offset:24640
    v_mfma_f32_16x16x32_bf16 v[208:211], v[168:171], a[112:115], v[208:211]
    ds_read_b64_tr_b16 v[134:135], v19 offset:25408
    ds_read_b64_tr_b16 v[136:137], v19 offset:24704
    v_mfma_f32_16x16x32_bf16 v[212:215], v[168:171], a[116:119], v[212:215]
    buffer_load_dwordx4 v6, s[8:11], s77 offen offset:2048 lds
    ds_read_b64_tr_b16 v[138:139], v19 offset:25472
    v_mfma_f32_16x16x32_bf16 v[116:119], v[184:187], a[112:115], v[116:119]
    ds_read_b128 v[152:155], v22 offset:0
    ds_read_b128 a[136:139], v112 offset:18432
    v_mfma_f32_16x16x32_bf16 v[192:195], v[172:175], a[120:123], v[192:195]
    ds_read_b128 a[140:143], v112 offset:16384
    ds_read_b64_tr_b16 v[140:141], v20 offset:24576
    v_mfma_f32_16x16x32_bf16 v[196:199], v[172:175], a[124:127], v[196:199]
    ds_read_b64_tr_b16 v[142:143], v20 offset:25344
    ds_read_b64_tr_b16 v[144:145], v20 offset:24640
    v_mfma_f32_16x16x32_bf16 v[200:203], v[176:179], a[120:123], v[200:203]
    s_add_u32 m0, s80, 0
    s_add_u32 s77, s84, s73
    buffer_load_dwordx4 v2, s[4:7], s77 offen lds
    ds_read_b64_tr_b16 v[146:147], v20 offset:25408
    v_mfma_f32_16x16x32_bf16 v[204:207], v[176:179], a[124:127], v[204:207]
    ds_read_b64_tr_b16 v[148:149], v20 offset:24704
    ds_read_b64_tr_b16 v[150:151], v20 offset:25472
    v_mfma_f32_16x16x32_bf16 v[208:211], v[180:183], a[120:123], v[208:211]
    buffer_load_dwordx4 v3, s[4:7], s77 offen offset:1024 lds
    ds_read_b128 v[156:159], v115 offset:0
    v_mfma_f32_16x16x32_bf16 v[212:215], v[180:183], a[124:127], v[212:215]
    v_mfma_f32_16x16x32_bf16 v[116:119], v[188:191], a[120:123], v[116:119]
    s_waitcnt lgkmcnt(14)
    v_mfma_f32_16x16x32_bf16 v[192:195], v[128:131], a[128:131], v[192:195]
    ds_read_b128 a[144:147], v16 offset:16384
    ds_read_b128 a[148:151], v16 offset:18432
    v_mfma_f32_16x16x32_bf16 v[196:199], v[128:131], a[132:135], v[196:199]
    s_add_u32 m0, s80, 2048
    s_add_u32 s77, s85, s73
    buffer_load_dwordx4 v2, s[4:7], s77 offen lds
    ds_read_b64_tr_b16 v[160:161], v19 offset:30720
    s_waitcnt lgkmcnt(15)
    v_mfma_f32_16x16x32_bf16 v[200:203], v[132:135], a[128:131], v[200:203]
    ds_read_b64_tr_b16 v[162:163], v19 offset:31488
    ds_read_b64_tr_b16 v[164:165], v19 offset:30784
    v_mfma_f32_16x16x32_bf16 v[204:207], v[132:135], a[132:135], v[204:207]
    ds_read_b64_tr_b16 v[166:167], v19 offset:31552
    ds_read_b64_tr_b16 v[168:169], v19 offset:30848
    s_waitcnt lgkmcnt(15)
    v_mfma_f32_16x16x32_bf16 v[208:211], v[136:139], a[128:131], v[208:211]
    ds_read_b64_tr_b16 v[170:171], v19 offset:31616
    ds_read_b128 v[184:187], v22 offset:64
    v_mfma_f32_16x16x32_bf16 v[212:215], v[136:139], a[132:135], v[212:215]
    buffer_load_dwordx4 v3, s[4:7], s77 offen offset:1024 lds
    ds_read_b128 a[152:155], v113 offset:18432
    v_mfma_f32_16x16x32_bf16 v[116:119], v[152:155], a[128:131], v[116:119]
    ds_read_b128 a[156:159], v113 offset:16384
    ds_read_b64_tr_b16 v[172:173], v20 offset:30720
    s_waitcnt lgkmcnt(15)
    v_mfma_f32_16x16x32_bf16 v[192:195], v[140:143], a[136:139], v[192:195]
    ds_read_b64_tr_b16 v[174:175], v20 offset:31488
    ds_read_b64_tr_b16 v[176:177], v20 offset:30784
    v_mfma_f32_16x16x32_bf16 v[196:199], v[140:143], a[140:143], v[196:199]
    ds_read_b64_tr_b16 v[178:179], v20 offset:31552
    ds_read_b64_tr_b16 v[180:181], v20 offset:30848
    v_mfma_f32_16x16x32_bf16 v[200:203], v[144:147], a[136:139], v[200:203]
    s_mul_i32 s77, s73, 1536
    s_add_u32 m0, s81, 0
    s_add_u32 s77, s77, s75
    buffer_load_dwordx4 v4, s[8:11], s77 offen offset:0 lds
    ds_read_b64_tr_b16 v[182:183], v20 offset:31616
    v_mfma_f32_16x16x32_bf16 v[204:207], v[144:147], a[140:143], v[204:207]
    ds_read_b128 v[188:191], v115 offset:64
    s_waitcnt lgkmcnt(15)
    v_mfma_f32_16x16x32_bf16 v[208:211], v[148:151], a[136:139], v[208:211]
    v_mfma_f32_16x16x32_bf16 v[212:215], v[148:151], a[140:143], v[212:215]
    v_mfma_f32_16x16x32_bf16 v[116:119], v[156:159], a[136:139], v[116:119]
    s_waitcnt lgkmcnt(0)
    buffer_load_dwordx4 v5, s[8:11], s77 offen offset:1024 lds
    buffer_load_dwordx4 v6, s[8:11], s77 offen offset:2048 lds
    s_mul_i32 s77, s73, 1536
    s_add_u32 m0, s81, 3072
    s_add_u32 s77, s77, s75
    s_add_u32 s77, s77, 49152
    buffer_load_dwordx4 v4, s[8:11], s77 offen offset:0 lds
    s_waitcnt vmcnt(8)
    s_barrier
    v_mfma_f32_16x16x32_bf16 v[192:195], v[160:163], a[144:147], v[192:195]
    v_add_u32 v22, s72, v21
    v_add_u32 v115, s72, v114
    v_mfma_f32_16x16x32_bf16 v[196:199], v[160:163], a[148:151], v[196:199]
    buffer_load_dwordx4 v5, s[8:11], s77 offen offset:1024 lds
    ds_read_b128 a[160:163], v15 offset:32768
    v_mfma_f32_16x16x32_bf16 v[200:203], v[164:167], a[144:147], v[200:203]
    ds_read_b128 a[164:167], v15 offset:34816
    ds_read_b64_tr_b16 v[128:129], v19 offset:49152
    v_mfma_f32_16x16x32_bf16 v[204:207], v[164:167], a[148:151], v[204:207]
    ds_read_b64_tr_b16 v[130:131], v19 offset:49920
    ds_read_b64_tr_b16 v[132:133], v19 offset:49216
    v_mfma_f32_16x16x32_bf16 v[208:211], v[168:171], a[144:147], v[208:211]
    ds_read_b64_tr_b16 v[134:135], v19 offset:49984
    ds_read_b64_tr_b16 v[136:137], v19 offset:49280
    v_mfma_f32_16x16x32_bf16 v[212:215], v[168:171], a[148:151], v[212:215]
    buffer_load_dwordx4 v6, s[8:11], s77 offen offset:2048 lds
    ds_read_b64_tr_b16 v[138:139], v19 offset:50048
    v_mfma_f32_16x16x32_bf16 v[116:119], v[184:187], a[144:147], v[116:119]
    ds_read_b128 v[152:155], v22 offset:0
    ds_read_b128 a[168:171], v112 offset:34816
    v_mfma_f32_16x16x32_bf16 v[192:195], v[172:175], a[152:155], v[192:195]
    ds_read_b128 a[172:175], v112 offset:32768
    ds_read_b64_tr_b16 v[140:141], v20 offset:49152
    v_mfma_f32_16x16x32_bf16 v[196:199], v[172:175], a[156:159], v[196:199]
    ds_read_b64_tr_b16 v[142:143], v20 offset:49920
    ds_read_b64_tr_b16 v[144:145], v20 offset:49216
    v_mfma_f32_16x16x32_bf16 v[200:203], v[176:179], a[152:155], v[200:203]
    s_add_u32 m0, s80, 16384
    s_add_u32 s77, s84, s74
    buffer_load_dwordx4 v2, s[4:7], s77 offen lds
    ds_read_b64_tr_b16 v[146:147], v20 offset:49984
    v_mfma_f32_16x16x32_bf16 v[204:207], v[176:179], a[156:159], v[204:207]
    ds_read_b64_tr_b16 v[148:149], v20 offset:49280
    ds_read_b64_tr_b16 v[150:151], v20 offset:50048
    v_mfma_f32_16x16x32_bf16 v[208:211], v[180:183], a[152:155], v[208:211]
    buffer_load_dwordx4 v3, s[4:7], s77 offen offset:1024 lds
    ds_read_b128 v[156:159], v115 offset:0
    v_mfma_f32_16x16x32_bf16 v[212:215], v[180:183], a[156:159], v[212:215]
    v_mfma_f32_16x16x32_bf16 v[116:119], v[188:191], a[152:155], v[116:119]
    s_waitcnt lgkmcnt(14)
    v_mfma_f32_16x16x32_bf16 v[192:195], v[128:131], a[160:163], v[192:195]
    ds_read_b128 a[176:179], v16 offset:32768
    ds_read_b128 a[180:183], v16 offset:34816
    v_mfma_f32_16x16x32_bf16 v[196:199], v[128:131], a[164:167], v[196:199]
    s_add_u32 m0, s80, 18432
    s_add_u32 s77, s85, s74
    buffer_load_dwordx4 v2, s[4:7], s77 offen lds
    ds_read_b64_tr_b16 v[160:161], v19 offset:55296
    s_waitcnt lgkmcnt(15)
    v_mfma_f32_16x16x32_bf16 v[200:203], v[132:135], a[160:163], v[200:203]
    ds_read_b64_tr_b16 v[162:163], v19 offset:56064
    ds_read_b64_tr_b16 v[164:165], v19 offset:55360
    v_mfma_f32_16x16x32_bf16 v[204:207], v[132:135], a[164:167], v[204:207]
    ds_read_b64_tr_b16 v[166:167], v19 offset:56128
    ds_read_b64_tr_b16 v[168:169], v19 offset:55424
    s_waitcnt lgkmcnt(15)
    v_mfma_f32_16x16x32_bf16 v[208:211], v[136:139], a[160:163], v[208:211]
    ds_read_b64_tr_b16 v[170:171], v19 offset:56192
    ds_read_b128 v[184:187], v22 offset:64
    v_mfma_f32_16x16x32_bf16 v[212:215], v[136:139], a[164:167], v[212:215]
    buffer_load_dwordx4 v3, s[4:7], s77 offen offset:1024 lds
    ds_read_b128 a[184:187], v113 offset:34816
    v_mfma_f32_16x16x32_bf16 v[116:119], v[152:155], a[160:163], v[116:119]
    ds_read_b128 a[188:191], v113 offset:32768
    ds_read_b64_tr_b16 v[172:173], v20 offset:55296
    s_waitcnt lgkmcnt(15)
    v_mfma_f32_16x16x32_bf16 v[192:195], v[140:143], a[168:171], v[192:195]
    ds_read_b64_tr_b16 v[174:175], v20 offset:56064
    ds_read_b64_tr_b16 v[176:177], v20 offset:55360
    v_mfma_f32_16x16x32_bf16 v[196:199], v[140:143], a[172:175], v[196:199]
    ds_read_b64_tr_b16 v[178:179], v20 offset:56128
    ds_read_b64_tr_b16 v[180:181], v20 offset:55424
    v_mfma_f32_16x16x32_bf16 v[200:203], v[144:147], a[168:171], v[200:203]
    s_mul_i32 s77, s74, 1536
    s_add_u32 m0, s81, 24576
    s_add_u32 s77, s77, s75
    buffer_load_dwordx4 v4, s[8:11], s77 offen offset:0 lds
    ds_read_b64_tr_b16 v[182:183], v20 offset:56192
    v_mfma_f32_16x16x32_bf16 v[204:207], v[144:147], a[172:175], v[204:207]
    ds_read_b128 v[188:191], v115 offset:64
    s_waitcnt lgkmcnt(15)
    v_mfma_f32_16x16x32_bf16 v[208:211], v[148:151], a[168:171], v[208:211]
    v_mfma_f32_16x16x32_bf16 v[212:215], v[148:151], a[172:175], v[212:215]
    v_mfma_f32_16x16x32_bf16 v[116:119], v[156:159], a[168:171], v[116:119]
    s_waitcnt lgkmcnt(0)
    buffer_load_dwordx4 v5, s[8:11], s77 offen offset:1024 lds
    buffer_load_dwordx4 v6, s[8:11], s77 offen offset:2048 lds
    s_mul_i32 s77, s74, 1536
    s_add_u32 m0, s81, 27648
    s_add_u32 s77, s77, s75
    s_add_u32 s77, s77, 49152
    buffer_load_dwordx4 v4, s[8:11], s77 offen offset:0 lds
    s_waitcnt vmcnt(8)
    s_barrier
    v_mfma_f32_16x16x32_bf16 v[192:195], v[160:163], a[176:179], v[192:195]
    v_add_u32 v22, s73, v21
    v_add_u32 v115, s73, v114
    v_mfma_f32_16x16x32_bf16 v[196:199], v[160:163], a[180:183], v[196:199]
    buffer_load_dwordx4 v5, s[8:11], s77 offen offset:1024 lds
    ds_read_b128 a[192:195], v15 offset:0
    v_mfma_f32_16x16x32_bf16 v[200:203], v[164:167], a[176:179], v[200:203]
    ds_read_b128 a[196:199], v15 offset:2048
    ds_read_b64_tr_b16 v[128:129], v19 offset:0
    v_mfma_f32_16x16x32_bf16 v[204:207], v[164:167], a[180:183], v[204:207]
    ds_read_b64_tr_b16 v[130:131], v19 offset:768
    ds_read_b64_tr_b16 v[132:133], v19 offset:64
    v_mfma_f32_16x16x32_bf16 v[208:211], v[168:171], a[176:179], v[208:211]
    ds_read_b64_tr_b16 v[134:135], v19 offset:832
    ds_read_b64_tr_b16 v[136:137], v19 offset:128
    v_mfma_f32_16x16x32_bf16 v[212:215], v[168:171], a[180:183], v[212:215]
    buffer_load_dwordx4 v6, s[8:11], s77 offen offset:2048 lds
    ds_read_b64_tr_b16 v[138:139], v19 offset:896
    v_mfma_f32_16x16x32_bf16 v[116:119], v[184:187], a[176:179], v[116:119]
    ds_read_b128 v[152:155], v22 offset:0
    ds_read_b128 a[200:203], v112 offset:2048
    v_mfma_f32_16x16x32_bf16 v[192:195], v[172:175], a[184:187], v[192:195]
    ds_read_b128 a[204:207], v112 offset:0
    ds_read_b64_tr_b16 v[140:141], v20 offset:0
    v_mfma_f32_16x16x32_bf16 v[196:199], v[172:175], a[188:191], v[196:199]
    ds_read_b64_tr_b16 v[142:143], v20 offset:768
    ds_read_b64_tr_b16 v[144:145], v20 offset:64
    v_mfma_f32_16x16x32_bf16 v[200:203], v[176:179], a[184:187], v[200:203]
    s_mul_i32 s77, s70, 1536
    s_add_u32 m0, s81, 49152
    s_add_u32 s77, s77, s76
    buffer_load_dwordx4 v4, s[8:11], s77 offen offset:0 lds
    ds_read_b64_tr_b16 v[146:147], v20 offset:832
    v_mfma_f32_16x16x32_bf16 v[204:207], v[176:179], a[188:191], v[204:207]
    ds_read_b64_tr_b16 v[148:149], v20 offset:128
    ds_read_b64_tr_b16 v[150:151], v20 offset:896
    v_mfma_f32_16x16x32_bf16 v[208:211], v[180:183], a[184:187], v[208:211]
    ds_read_b128 v[156:159], v115 offset:0
    v_mfma_f32_16x16x32_bf16 v[212:215], v[180:183], a[188:191], v[212:215]
    buffer_load_dwordx4 v5, s[8:11], s77 offen offset:1024 lds
    v_mfma_f32_16x16x32_bf16 v[116:119], v[188:191], a[184:187], v[116:119]
    s_waitcnt lgkmcnt(14)
    v_mfma_f32_16x16x32_bf16 v[192:195], v[128:131], a[192:195], v[192:195]
    ds_read_b128 a[208:211], v16 offset:0
    ds_read_b128 a[212:215], v16 offset:2048
    v_mfma_f32_16x16x32_bf16 v[196:199], v[128:131], a[196:199], v[196:199]
    ds_read_b64_tr_b16 v[160:161], v19 offset:6144
    s_waitcnt lgkmcnt(15)
    v_mfma_f32_16x16x32_bf16 v[200:203], v[132:135], a[192:195], v[200:203]
    ds_read_b64_tr_b16 v[162:163], v19 offset:6912
    ds_read_b64_tr_b16 v[164:165], v19 offset:6208
    v_mfma_f32_16x16x32_bf16 v[204:207], v[132:135], a[196:199], v[204:207]
    ds_read_b64_tr_b16 v[166:167], v19 offset:6976
    ds_read_b64_tr_b16 v[168:169], v19 offset:6272
    s_waitcnt lgkmcnt(15)
    v_mfma_f32_16x16x32_bf16 v[208:211], v[136:139], a[192:195], v[208:211]
    ds_read_b64_tr_b16 v[170:171], v19 offset:7040
    ds_read_b128 v[184:187], v22 offset:64
    v_mfma_f32_16x16x32_bf16 v[212:215], v[136:139], a[196:199], v[212:215]
    buffer_load_dwordx4 v6, s[8:11], s77 offen offset:2048 lds
    ds_read_b128 a[216:219], v113 offset:2048
    v_mfma_f32_16x16x32_bf16 v[116:119], v[152:155], a[192:195], v[116:119]
    ds_read_b128 a[220:223], v113 offset:0
    ds_read_b64_tr_b16 v[172:173], v20 offset:6144
    s_waitcnt lgkmcnt(15)
    v_mfma_f32_16x16x32_bf16 v[192:195], v[140:143], a[200:203], v[192:195]
    ds_read_b64_tr_b16 v[174:175], v20 offset:6912
    ds_read_b64_tr_b16 v[176:177], v20 offset:6208
    v_mfma_f32_16x16x32_bf16 v[196:199], v[140:143], a[204:207], v[196:199]
    ds_read_b64_tr_b16 v[178:179], v20 offset:6976
    ds_read_b64_tr_b16 v[180:181], v20 offset:6272
    v_mfma_f32_16x16x32_bf16 v[200:203], v[144:147], a[200:203], v[200:203]
    s_mul_i32 s77, s70, 1536
    s_add_u32 m0, s81, 52224
    s_add_u32 s77, s77, s76
    s_add_u32 s77, s77, 49152
    buffer_load_dwordx4 v4, s[8:11], s77 offen offset:0 lds
    ds_read_b64_tr_b16 v[182:183], v20 offset:7040
    v_mfma_f32_16x16x32_bf16 v[204:207], v[144:147], a[204:207], v[204:207]
    ds_read_b128 v[188:191], v115 offset:64
    s_waitcnt lgkmcnt(15)
    v_mfma_f32_16x16x32_bf16 v[208:211], v[148:151], a[200:203], v[208:211]
    v_mfma_f32_16x16x32_bf16 v[212:215], v[148:151], a[204:207], v[212:215]
    v_mfma_f32_16x16x32_bf16 v[116:119], v[156:159], a[200:203], v[116:119]
    s_waitcnt lgkmcnt(0)
    buffer_load_dwordx4 v5, s[8:11], s77 offen offset:1024 lds
    buffer_load_dwordx4 v6, s[8:11], s77 offen offset:2048 lds
    s_waitcnt vmcnt(6)
    s_barrier
    s_mul_i32 s77, s71, 1536
    s_add_u32 m0, s81, 0
    s_add_u32 s77, s77, s76
    buffer_load_dwordx4 v4, s[8:11], s77 offen offset:0 lds
    v_mfma_f32_16x16x32_bf16 v[192:195], v[160:163], a[208:211], v[192:195]
    v_add_u32 v22, s74, v21
    v_add_u32 v115, s74, v114
    v_mfma_f32_16x16x32_bf16 v[196:199], v[160:163], a[212:215], v[196:199]
    buffer_load_dwordx4 v5, s[8:11], s77 offen offset:1024 lds
    ds_read_b128 a[224:227], v15 offset:16384
    v_mfma_f32_16x16x32_bf16 v[200:203], v[164:167], a[208:211], v[200:203]
    ds_read_b128 a[228:231], v15 offset:18432
    ds_read_b64_tr_b16 v[128:129], v19 offset:24576
    v_mfma_f32_16x16x32_bf16 v[204:207], v[164:167], a[212:215], v[204:207]
    ds_read_b64_tr_b16 v[130:131], v19 offset:25344
    ds_read_b64_tr_b16 v[132:133], v19 offset:24640
    v_mfma_f32_16x16x32_bf16 v[208:211], v[168:171], a[208:211], v[208:211]
    ds_read_b64_tr_b16 v[134:135], v19 offset:25408
    ds_read_b64_tr_b16 v[136:137], v19 offset:24704
    v_mfma_f32_16x16x32_bf16 v[212:215], v[168:171], a[212:215], v[212:215]
    ds_read_b64_tr_b16 v[138:139], v19 offset:25472
    v_mfma_f32_16x16x32_bf16 v[116:119], v[184:187], a[208:211], v[116:119]
    ds_read_b128 v[152:155], v22 offset:0
    ds_read_b128 a[232:235], v112 offset:18432
    v_mfma_f32_16x16x32_bf16 v[192:195], v[172:175], a[216:219], v[192:195]
    ds_read_b128 a[236:239], v112 offset:16384
    ds_read_b64_tr_b16 v[140:141], v20 offset:24576
    v_mfma_f32_16x16x32_bf16 v[196:199], v[172:175], a[220:223], v[196:199]
    ds_read_b64_tr_b16 v[142:143], v20 offset:25344
    ds_read_b64_tr_b16 v[144:145], v20 offset:24640
    v_mfma_f32_16x16x32_bf16 v[200:203], v[176:179], a[216:219], v[200:203]
    buffer_load_dwordx4 v6, s[8:11], s77 offen offset:2048 lds
    ds_read_b64_tr_b16 v[146:147], v20 offset:25408
    v_mfma_f32_16x16x32_bf16 v[204:207], v[176:179], a[220:223], v[204:207]
    ds_read_b64_tr_b16 v[148:149], v20 offset:24704
    ds_read_b64_tr_b16 v[150:151], v20 offset:25472
    v_mfma_f32_16x16x32_bf16 v[208:211], v[180:183], a[216:219], v[208:211]
    s_mul_i32 s77, s71, 1536
    s_add_u32 m0, s81, 3072
    s_add_u32 s77, s77, s76
    s_add_u32 s77, s77, 49152
    buffer_load_dwordx4 v4, s[8:11], s77 offen offset:0 lds
    ds_read_b128 v[156:159], v115 offset:0
    v_mfma_f32_16x16x32_bf16 v[212:215], v[180:183], a[220:223], v[212:215]
    v_mfma_f32_16x16x32_bf16 v[116:119], v[188:191], a[216:219], v[116:119]
    s_waitcnt lgkmcnt(14)
    v_mfma_f32_16x16x32_bf16 v[192:195], v[128:131], a[224:227], v[192:195]
    ds_read_b128 a[240:243], v16 offset:16384
    ds_read_b128 a[244:247], v16 offset:18432
    v_mfma_f32_16x16x32_bf16 v[196:199], v[128:131], a[228:231], v[196:199]
    ds_read_b64_tr_b16 v[160:161], v19 offset:30720
    s_waitcnt lgkmcnt(15)
    v_mfma_f32_16x16x32_bf16 v[200:203], v[132:135], a[224:227], v[200:203]
    ds_read_b64_tr_b16 v[162:163], v19 offset:31488
    ds_read_b64_tr_b16 v[164:165], v19 offset:30784
    v_mfma_f32_16x16x32_bf16 v[204:207], v[132:135], a[228:231], v[204:207]
    ds_read_b64_tr_b16 v[166:167], v19 offset:31552
    ds_read_b64_tr_b16 v[168:169], v19 offset:30848
    s_waitcnt lgkmcnt(15)
    v_mfma_f32_16x16x32_bf16 v[208:211], v[136:139], a[224:227], v[208:211]
    ds_read_b64_tr_b16 v[170:171], v19 offset:31616
    ds_read_b128 v[184:187], v22 offset:64
    v_mfma_f32_16x16x32_bf16 v[212:215], v[136:139], a[228:231], v[212:215]
    buffer_load_dwordx4 v5, s[8:11], s77 offen offset:1024 lds
    ds_read_b128 a[248:251], v113 offset:18432
    v_mfma_f32_16x16x32_bf16 v[116:119], v[152:155], a[224:227], v[116:119]
    ds_read_b128 a[252:255], v113 offset:16384
    ds_read_b64_tr_b16 v[172:173], v20 offset:30720
    s_waitcnt lgkmcnt(15)
    v_mfma_f32_16x16x32_bf16 v[192:195], v[140:143], a[232:235], v[192:195]
    ds_read_b64_tr_b16 v[174:175], v20 offset:31488
    ds_read_b64_tr_b16 v[176:177], v20 offset:30784
    v_mfma_f32_16x16x32_bf16 v[196:199], v[140:143], a[236:239], v[196:199]
    ds_read_b64_tr_b16 v[178:179], v20 offset:31552
    ds_read_b64_tr_b16 v[180:181], v20 offset:30848
    v_mfma_f32_16x16x32_bf16 v[200:203], v[144:147], a[232:235], v[200:203]
    buffer_load_dwordx4 v6, s[8:11], s77 offen offset:2048 lds
    ds_read_b64_tr_b16 v[182:183], v20 offset:31616
    v_mfma_f32_16x16x32_bf16 v[204:207], v[144:147], a[236:239], v[204:207]
    ds_read_b128 v[188:191], v115 offset:64
    s_waitcnt lgkmcnt(15)
    v_mfma_f32_16x16x32_bf16 v[208:211], v[148:151], a[232:235], v[208:211]
    v_mfma_f32_16x16x32_bf16 v[212:215], v[148:151], a[236:239], v[212:215]
    v_mfma_f32_16x16x32_bf16 v[116:119], v[156:159], a[232:235], v[116:119]
    s_waitcnt lgkmcnt(0)
    s_barrier
    v_mfma_f32_16x16x32_bf16 v[192:195], v[160:163], a[240:243], v[192:195]
    s_mul_i32 s77, s72, 1536
    s_add_u32 m0, s81, 24576
    s_add_u32 s77, s77, s76
    buffer_load_dwordx4 v4, s[8:11], s77 offen offset:0 lds
    v_mfma_f32_16x16x32_bf16 v[196:199], v[160:163], a[244:247], v[196:199]
    buffer_load_dwordx4 v5, s[8:11], s77 offen offset:1024 lds
    v_mfma_f32_16x16x32_bf16 v[200:203], v[164:167], a[240:243], v[200:203]
    v_mfma_f32_16x16x32_bf16 v[204:207], v[164:167], a[244:247], v[204:207]
    v_mfma_f32_16x16x32_bf16 v[208:211], v[168:171], a[240:243], v[208:211]
    v_mfma_f32_16x16x32_bf16 v[212:215], v[168:171], a[244:247], v[212:215]
    v_mfma_f32_16x16x32_bf16 v[116:119], v[184:187], a[240:243], v[116:119]
    v_mfma_f32_16x16x32_bf16 v[192:195], v[172:175], a[248:251], v[192:195]
    buffer_load_dwordx4 v6, s[8:11], s77 offen offset:2048 lds
    v_mfma_f32_16x16x32_bf16 v[196:199], v[172:175], a[252:255], v[196:199]
    v_mfma_f32_16x16x32_bf16 v[200:203], v[176:179], a[248:251], v[200:203]
    v_mfma_f32_16x16x32_bf16 v[204:207], v[176:179], a[252:255], v[204:207]
    v_mfma_f32_16x16x32_bf16 v[208:211], v[180:183], a[248:251], v[208:211]
    v_mfma_f32_16x16x32_bf16 v[212:215], v[180:183], a[252:255], v[212:215]
    s_mul_i32 s77, s72, 1536
    s_add_u32 m0, s81, 27648
    s_add_u32 s77, s77, s76
    s_add_u32 s77, s77, 49152
    buffer_load_dwordx4 v4, s[8:11], s77 offen offset:0 lds
    v_mfma_f32_16x16x32_bf16 v[116:119], v[188:191], a[248:251], v[116:119]
    v_pk_mul_f32 v[64:65], v[192:193], v[192:193]
    v_pk_mul_f32 v[66:67], v[194:195], v[194:195]
    v_pk_fma_f32 v[64:65], v[64:65], s[92:93], v[248:249]
    v_pk_fma_f32 v[66:67], v[66:67], s[92:93], v[248:249]
    v_pk_mul_f32 v[64:65], v[64:65], v[192:193]
    v_pk_mul_f32 v[66:67], v[66:67], v[194:195]
    v_exp_f32 v64, v64
    v_exp_f32 v65, v65
    v_exp_f32 v66, v66
    v_exp_f32 v67, v67
    buffer_load_dwordx4 v5, s[8:11], s77 offen offset:1024 lds
    v_pk_add_f32 v[64:65], v[64:65], 1.0 op_sel_hi:[1,0]
    v_pk_add_f32 v[66:67], v[66:67], 1.0 op_sel_hi:[1,0]
    v_rcp_f32 v64, v64
    v_rcp_f32 v65, v65
    v_rcp_f32 v66, v66
    v_rcp_f32 v67, v67
    v_pk_mul_f32 v[192:193], v[192:193], v[64:65]
    v_pk_mul_f32 v[194:195], v[194:195], v[66:67]
    v_pk_mul_f32 v[68:69], v[196:197], v[196:197]
    v_pk_mul_f32 v[70:71], v[198:199], v[198:199]
    v_pk_fma_f32 v[68:69], v[68:69], s[92:93], v[248:249]
    v_pk_fma_f32 v[70:71], v[70:71], s[92:93], v[248:249]
    v_pk_mul_f32 v[68:69], v[68:69], v[196:197]
    v_pk_mul_f32 v[70:71], v[70:71], v[198:199]
    v_exp_f32 v68, v68
    buffer_load_dwordx4 v6, s[8:11], s77 offen offset:2048 lds
    v_exp_f32 v69, v69
    v_exp_f32 v70, v70
    v_exp_f32 v71, v71
    v_pk_add_f32 v[68:69], v[68:69], 1.0 op_sel_hi:[1,0]
    v_pk_add_f32 v[70:71], v[70:71], 1.0 op_sel_hi:[1,0]
    v_rcp_f32 v68, v68
    v_rcp_f32 v69, v69
    v_rcp_f32 v70, v70
    v_rcp_f32 v71, v71
    v_pk_mul_f32 v[196:197], v[196:197], v[68:69]
    v_pk_mul_f32 v[198:199], v[198:199], v[70:71]
    v_pk_mul_f32 v[72:73], v[200:201], v[200:201]
    s_add_u32 m0, s100, 131072
    s_nop 0
    buffer_load_dwordx4 v32, s[28:31], s101 offen lds
    v_pk_mul_f32 v[74:75], v[202:203], v[202:203]
    v_pk_fma_f32 v[72:73], v[72:73], s[92:93], v[248:249]
    v_pk_fma_f32 v[74:75], v[74:75], s[92:93], v[248:249]
    v_pk_mul_f32 v[72:73], v[72:73], v[200:201]
    v_pk_mul_f32 v[74:75], v[74:75], v[202:203]
    v_exp_f32 v72, v72
    v_exp_f32 v73, v73
    v_exp_f32 v74, v74
    v_exp_f32 v75, v75
    v_pk_add_f32 v[72:73], v[72:73], 1.0 op_sel_hi:[1,0]
    s_add_u32 m0, s83, 0
    s_xor_b32 s77, s86, 0
    buffer_load_dwordx4 v10, s[12:15], s77 offen lds
    v_pk_add_f32 v[74:75], v[74:75], 1.0 op_sel_hi:[1,0]
    v_rcp_f32 v72, v72
    v_rcp_f32 v73, v73
    v_rcp_f32 v74, v74
    v_rcp_f32 v75, v75
    v_pk_mul_f32 v[200:201], v[200:201], v[72:73]
    v_pk_mul_f32 v[202:203], v[202:203], v[74:75]
    v_pk_mul_f32 v[76:77], v[204:205], v[204:205]
    v_pk_mul_f32 v[78:79], v[206:207], v[206:207]
    v_pk_fma_f32 v[76:77], v[76:77], s[92:93], v[248:249]
    v_pk_fma_f32 v[78:79], v[78:79], s[92:93], v[248:249]
    v_pk_mul_f32 v[76:77], v[76:77], v[204:205]
    v_pk_mul_f32 v[78:79], v[78:79], v[206:207]
    v_exp_f32 v76, v76
    v_exp_f32 v77, v77
    v_exp_f32 v78, v78
    v_exp_f32 v79, v79
    v_pk_add_f32 v[76:77], v[76:77], 1.0 op_sel_hi:[1,0]
    v_pk_add_f32 v[78:79], v[78:79], 1.0 op_sel_hi:[1,0]
    v_rcp_f32 v76, v76
    v_rcp_f32 v77, v77
    buffer_load_dwordx4 v11, s[12:15], s77 offen offset:1024 lds
    v_rcp_f32 v78, v78
    v_rcp_f32 v79, v79
    v_pk_mul_f32 v[204:205], v[204:205], v[76:77]
    v_pk_mul_f32 v[206:207], v[206:207], v[78:79]
    v_pk_mul_f32 v[80:81], v[208:209], v[208:209]
    v_pk_mul_f32 v[82:83], v[210:211], v[210:211]
    v_pk_fma_f32 v[80:81], v[80:81], s[92:93], v[248:249]
    v_pk_fma_f32 v[82:83], v[82:83], s[92:93], v[248:249]
    v_pk_mul_f32 v[80:81], v[80:81], v[208:209]
    v_pk_mul_f32 v[82:83], v[82:83], v[210:211]
    v_exp_f32 v80, v80
    v_exp_f32 v81, v81
    v_exp_f32 v82, v82
    v_exp_f32 v83, v83
    v_pk_add_f32 v[80:81], v[80:81], 1.0 op_sel_hi:[1,0]
    v_pk_add_f32 v[82:83], v[82:83], 1.0 op_sel_hi:[1,0]
    v_rcp_f32 v80, v80
    v_rcp_f32 v81, v81
    v_rcp_f32 v82, v82
    v_rcp_f32 v83, v83
    v_pk_mul_f32 v[208:209], v[208:209], v[80:81]
    v_pk_mul_f32 v[210:211], v[210:211], v[82:83]
    v_pk_mul_f32 v[84:85], v[212:213], v[212:213]
    s_add_u32 m0, s83, 2048
    s_xor_b32 s77, s87, 0
    buffer_load_dwordx4 v10, s[12:15], s77 offen lds
    v_pk_mul_f32 v[86:87], v[214:215], v[214:215]
    v_pk_fma_f32 v[84:85], v[84:85], s[92:93], v[248:249]
    v_pk_fma_f32 v[86:87], v[86:87], s[92:93], v[248:249]
    v_pk_mul_f32 v[84:85], v[84:85], v[212:213]
    v_pk_mul_f32 v[86:87], v[86:87], v[214:215]
    v_exp_f32 v84, v84
    v_exp_f32 v85, v85
    v_exp_f32 v86, v86
    v_exp_f32 v87, v87
    v_pk_add_f32 v[84:85], v[84:85], 1.0 op_sel_hi:[1,0]
    v_pk_add_f32 v[86:87], v[86:87], 1.0 op_sel_hi:[1,0]
    v_rcp_f32 v84, v84
    v_rcp_f32 v85, v85
    v_rcp_f32 v86, v86
    v_rcp_f32 v87, v87
    v_pk_mul_f32 v[212:213], v[212:213], v[84:85]
    v_pk_mul_f32 v[214:215], v[214:215], v[86:87]
    v_pk_add_f32 v[44:45], v[196:197], v[198:199]
    v_pk_mul_f32 v[46:47], v[196:197], v[196:197]
    v_pk_fma_f32 v[46:47], v[198:199], v[198:199], v[46:47]
    v_pk_add_f32 v[44:45], v[44:45], v[204:205]
    v_pk_fma_f32 v[46:47], v[204:205], v[204:205], v[46:47]
    v_pk_add_f32 v[44:45], v[44:45], v[206:207]
    buffer_load_dwordx4 v11, s[12:15], s77 offen offset:1024 lds
    v_pk_fma_f32 v[46:47], v[206:207], v[206:207], v[46:47]
    v_pk_add_f32 v[44:45], v[44:45], v[212:213]
    v_pk_fma_f32 v[46:47], v[212:213], v[212:213], v[46:47]
    v_pk_add_f32 v[44:45], v[44:45], v[214:215]
    v_pk_fma_f32 v[46:47], v[214:215], v[214:215], v[46:47]
    v_add_f32 v44, v44, v45
    v_add_f32 v45, v46, v47
    ds_write_b64 v120, v[44:45]
    v_xor_b32 v120, 512, v120
    v_pk_add_f32 v[40:41], v[192:193], v[194:195]
    v_pk_mul_f32 v[42:43], v[192:193], v[192:193]
    v_pk_fma_f32 v[42:43], v[194:195], v[194:195], v[42:43]
    v_pk_add_f32 v[40:41], v[40:41], v[200:201]
    v_pk_fma_f32 v[42:43], v[200:201], v[200:201], v[42:43]
    v_pk_add_f32 v[40:41], v[40:41], v[202:203]
    v_pk_fma_f32 v[42:43], v[202:203], v[202:203], v[42:43]
    v_pk_add_f32 v[40:41], v[40:41], v[208:209]
    v_pk_fma_f32 v[42:43], v[208:209], v[208:209], v[42:43]
    v_pk_add_f32 v[40:41], v[40:41], v[210:211]
    v_pk_fma_f32 v[42:43], v[210:211], v[210:211], v[42:43]
    v_add_f32 v40, v40, v41
    v_add_f32 v42, v42, v43
    s_lshl_b32 s78, s65, 2
    s_add_u32 s78, s78, s64
    s_lshl_b32 s78, s78, 11
    s_add_u32 s95, s78, 131072
    s_lshl_b32 s78, s66, 8
    s_add_u32 s78, s78, s95
    s_xor_b32 s96, s95, 2048
    s_waitcnt lgkmcnt(0)
    s_barrier
    s_add_u32 m0, s83, 4096
    s_xor_b32 s77, s88, 0
    buffer_load_dwordx4 v10, s[12:15], s77 offen lds
    ds_read_b64 v[44:45], v120
    v_mov_b32 v41, s68
    v_mov_b32 v43, s68
    s_waitcnt lgkmcnt(0)
    v_add_f32 v40, v40, v44
    v_add_f32 v42, v42, v45
    v_mov_b32 v44, v40
    v_mov_b32 v45, v42
    s_nop 0
    v_permlane32_swap_b32 v44, v40
    v_permlane32_swap_b32 v45, v42
    v_add_f32 v40, v40, v44
    buffer_load_dwordx4 v11, s[12:15], s77 offen offset:1024 lds
    v_add_f32 v42, v42, v45
    v_mov_b32 v44, v40
    v_mov_b32 v45, v42
    s_nop 0
    v_permlane16_swap_b32 v44, v40
    v_permlane16_swap_b32 v45, v42
    v_add_f32 v40, v40, v44
    v_add_f32 v42, v42, v45
    s_mov_b64 exec, 0xffff
    buffer_store_dwordx4 v[40:43], v12, s[20:23], s78 offen sc1
    s_mov_b64 exec, -1
    v_mov_b32 v52, -1
    v_mov_b32 v53, -1
    v_mov_b32 v54, -1
    v_mov_b32 v55, -1
    s_mul_i32 s78, s65, 96
    s_add_u32 s78, s78, s66
    s_lshl_b32 s78, s78, 10
    s_add_u32 s78, s78, 0x502000
    buffer_store_dwordx4 v[52:55], v255, s[20:23], s78 offen sc1
    s_add_u32 s78, s78, 8192
    buffer_store_dwordx4 v[52:55], v255, s[20:23], s78 offen sc1
    s_waitcnt vmcnt(22)
    s_barrier
    ds_read_b64_tr_b16 v[128:129], v19 offset:49152
    ds_read_b64_tr_b16 v[130:131], v19 offset:49920
    ds_read_b64_tr_b16 v[132:133], v19 offset:49216
    s_add_u32 m0, s83, 6144
    s_xor_b32 s77, s89, 0
    buffer_load_dwordx4 v10, s[12:15], s77 offen lds
    ds_read_b64_tr_b16 v[134:135], v19 offset:49984
    ds_read_b64_tr_b16 v[136:137], v19 offset:49280
    ds_read_b64_tr_b16 v[138:139], v19 offset:50048
    ds_read_b64_tr_b16 v[140:141], v20 offset:49152
    ds_read_b64_tr_b16 v[142:143], v20 offset:49920
    ds_read_b64_tr_b16 v[144:145], v20 offset:49216
    ds_read_b64_tr_b16 v[146:147], v20 offset:49984
    ds_read_b64_tr_b16 v[148:149], v20 offset:49280
    ds_read_b64_tr_b16 v[150:151], v20 offset:50048
    s_waitcnt lgkmcnt(10)
    v_mfma_f32_16x16x32_bf16 v[216:219], v[128:131], a[96:99], 0
    ds_read_b64_tr_b16 v[160:161], v19 offset:55296
    ds_read_b64_tr_b16 v[162:163], v19 offset:56064
    v_mfma_f32_16x16x32_bf16 v[220:223], v[128:131], a[100:103], 0
    ds_read_b64_tr_b16 v[164:165], v19 offset:55360
    s_waitcnt lgkmcnt(11)
    v_mfma_f32_16x16x32_bf16 v[224:227], v[132:135], a[96:99], 0
    ds_read_b64_tr_b16 v[166:167], v19 offset:56128
    ds_read_b64_tr_b16 v[168:169], v19 offset:55424
    v_mfma_f32_16x16x32_bf16 v[228:231], v[132:135], a[100:103], 0
    ds_read_b64_tr_b16 v[170:171], v19 offset:56192
    ds_read_b64_tr_b16 v[172:173], v20 offset:55296
    s_waitcnt lgkmcnt(13)
    v_mfma_f32_16x16x32_bf16 v[232:235], v[136:139], a[96:99], 0
    ds_read_b64_tr_b16 v[174:175], v20 offset:56064
    ds_read_b64_tr_b16 v[176:177], v20 offset:55360
    v_mfma_f32_16x16x32_bf16 v[236:239], v[136:139], a[100:103], 0
    buffer_load_dwordx4 v11, s[12:15], s77 offen offset:1024 lds
    ds_read_b64_tr_b16 v[178:179], v20 offset:56128
    s_waitcnt lgkmcnt(14)
    v_mfma_f32_16x16x32_bf16 v[216:219], v[140:143], a[104:107], v[216:219]
    ds_read_b64_tr_b16 v[180:181], v20 offset:55424
    ds_read_b64_tr_b16 v[182:183], v20 offset:56192
    v_mfma_f32_16x16x32_bf16 v[220:223], v[140:143], a[108:111], v[220:223]
    s_waitcnt lgkmcnt(14)
    v_mfma_f32_16x16x32_bf16 v[224:227], v[144:147], a[104:107], v[224:227]
    v_mfma_f32_16x16x32_bf16 v[228:231], v[144:147], a[108:111], v[228:231]
    s_waitcnt lgkmcnt(12)
    v_mfma_f32_16x16x32_bf16 v[232:235], v[148:151], a[104:107], v[232:235]
    v_mfma_f32_16x16x32_bf16 v[236:239], v[148:151], a[108:111], v[236:239]
    s_waitcnt lgkmcnt(0)
    s_waitcnt vmcnt(18)
    s_barrier
    v_mfma_f32_16x16x32_bf16 v[216:219], v[160:163], a[112:115], v[216:219]
    ds_read_b64_tr_b16 v[128:129], v19 offset:0
    ds_read_b64_tr_b16 v[130:131], v19 offset:768
    v_mfma_f32_16x16x32_bf16 v[220:223], v[160:163], a[116:119], v[220:223]
    s_add_u32 m0, s83, 8192
    s_xor_b32 s77, s86, 128
    buffer_load_dwordx4 v10, s[12:15], s77 offen lds
    ds_read_b64_tr_b16 v[132:133], v19 offset:64
    v_mfma_f32_16x16x32_bf16 v[224:227], v[164:167], a[112:115], v[224:227]
    ds_read_b64_tr_b16 v[134:135], v19 offset:832
    ds_read_b64_tr_b16 v[136:137], v19 offset:128
    v_mfma_f32_16x16x32_bf16 v[228:231], v[164:167], a[116:119], v[228:231]
    ds_read_b64_tr_b16 v[138:139], v19 offset:896
    ds_read_b64_tr_b16 v[140:141], v20 offset:0
    v_mfma_f32_16x16x32_bf16 v[232:235], v[168:171], a[112:115], v[232:235]
    ds_read_b64_tr_b16 v[142:143], v20 offset:768
    ds_read_b64_tr_b16 v[144:145], v20 offset:64
    v_mfma_f32_16x16x32_bf16 v[236:239], v[168:171], a[116:119], v[236:239]
    ds_read_b64_tr_b16 v[146:147], v20 offset:832
    v_mfma_f32_16x16x32_bf16 v[216:219], v[172:175], a[120:123], v[216:219]
    ds_read_b64_tr_b16 v[148:149], v20 offset:128
    ds_read_b64_tr_b16 v[150:151], v20 offset:896
    v_mfma_f32_16x16x32_bf16 v[220:223], v[172:175], a[124:127], v[220:223]
    v_mfma_f32_16x16x32_bf16 v[224:227], v[176:179], a[120:123], v[224:227]
    buffer_load_dwordx4 v11, s[12:15], s77 offen offset:1024 lds
    v_mfma_f32_16x16x32_bf16 v[228:231], v[176:179], a[124:127], v[228:231]
    v_mfma_f32_16x16x32_bf16 v[232:235], v[180:183], a[120:123], v[232:235]
    v_mfma_f32_16x16x32_bf16 v[236:239], v[180:183], a[124:127], v[236:239]
    s_waitcnt lgkmcnt(10)
    v_mfma_f32_16x16x32_bf16 v[216:219], v[128:131], a[128:131], v[216:219]
    ds_read_b64_tr_b16 v[160:161], v19 offset:6144
    ds_read_b64_tr_b16 v[162:163], v19 offset:6912
    v_mfma_f32_16x16x32_bf16 v[220:223], v[128:131], a[132:135], v[220:223]
    ds_read_b64_tr_b16 v[164:165], v19 offset:6208
    s_waitcnt lgkmcnt(11)
    v_mfma_f32_16x16x32_bf16 v[224:227], v[132:135], a[128:131], v[224:227]
    ds_read_b64_tr_b16 v[166:167], v19 offset:6976
    ds_read_b64_tr_b16 v[168:169], v19 offset:6272
    v_mfma_f32_16x16x32_bf16 v[228:231], v[132:135], a[132:135], v[228:231]
    ds_read_b64_tr_b16 v[170:171], v19 offset:7040
    ds_read_b64_tr_b16 v[172:173], v20 offset:6144
    s_waitcnt lgkmcnt(13)
    v_mfma_f32_16x16x32_bf16 v[232:235], v[136:139], a[128:131], v[232:235]
    ds_read_b64_tr_b16 v[174:175], v20 offset:6912
    ds_read_b64_tr_b16 v[176:177], v20 offset:6208
    v_mfma_f32_16x16x32_bf16 v[236:239], v[136:139], a[132:135], v[236:239]
    ds_read_b64_tr_b16 v[178:179], v20 offset:6976
    s_waitcnt lgkmcnt(14)
    v_mfma_f32_16x16x32_bf16 v[216:219], v[140:143], a[136:139], v[216:219]
    ds_read_b64_tr_b16 v[180:181], v20 offset:6272
    ds_read_b64_tr_b16 v[182:183], v20 offset:7040
    v_mfma_f32_16x16x32_bf16 v[220:223], v[140:143], a[140:143], v[220:223]
    s_waitcnt vmcnt(11)
    ds_read_b128 a[0:3], v17 offset:0
    ds_read_b128 a[4:7], v18 offset:0
    s_waitcnt lgkmcnt(15)
    v_mfma_f32_16x16x32_bf16 v[224:227], v[144:147], a[136:139], v[224:227]
    s_mul_i32 s77, s73, 1536
    s_add_u32 m0, s81, 49152
    s_add_u32 s77, s77, s76
    buffer_load_dwordx4 v4, s[8:11], s77 offen offset:0 lds
    v_mfma_f32_16x16x32_bf16 v[228:231], v[144:147], a[140:143], v[228:231]
    s_waitcnt lgkmcnt(14)
    v_mfma_f32_16x16x32_bf16 v[232:235], v[148:151], a[136:139], v[232:235]
    buffer_load_dwordx4 v5, s[8:11], s77 offen offset:1024 lds
    v_mfma_f32_16x16x32_bf16 v[236:239], v[148:151], a[140:143], v[236:239]
    s_waitcnt lgkmcnt(0)
    s_barrier
    v_mfma_f32_16x16x32_bf16 v[216:219], v[160:163], a[144:147], v[216:219]
    ds_read_b64_tr_b16 v[128:129], v19 offset:24576
    ds_read_b64_tr_b16 v[130:131], v19 offset:25344
    v_mfma_f32_16x16x32_bf16 v[220:223], v[160:163], a[148:151], v[220:223]
    buffer_load_dwordx4 v6, s[8:11], s77 offen offset:2048 lds
    ds_read_b64_tr_b16 v[132:133], v19 offset:24640
    v_mfma_f32_16x16x32_bf16 v[224:227], v[164:167], a[144:147], v[224:227]
    ds_read_b64_tr_b16 v[134:135], v19 offset:25408
    ds_read_b64_tr_b16 v[136:137], v19 offset:24704
    v_mfma_f32_16x16x32_bf16 v[228:231], v[164:167], a[148:151], v[228:231]
    ds_read_b64_tr_b16 v[138:139], v19 offset:25472
    ds_read_b64_tr_b16 v[140:141], v20 offset:24576
    v_mfma_f32_16x16x32_bf16 v[232:235], v[168:171], a[144:147], v[232:235]
    ds_read_b64_tr_b16 v[142:143], v20 offset:25344
    ds_read_b64_tr_b16 v[144:145], v20 offset:24640
    v_mfma_f32_16x16x32_bf16 v[236:239], v[168:171], a[148:151], v[236:239]
    ds_read_b64_tr_b16 v[146:147], v20 offset:25408
    v_mfma_f32_16x16x32_bf16 v[216:219], v[172:175], a[152:155], v[216:219]
    ds_read_b64_tr_b16 v[148:149], v20 offset:24704
    ds_read_b64_tr_b16 v[150:151], v20 offset:25472
    v_mfma_f32_16x16x32_bf16 v[220:223], v[172:175], a[156:159], v[220:223]
    s_mul_i32 s77, s73, 1536
    s_add_u32 m0, s81, 52224
    s_add_u32 s77, s77, s76
    s_add_u32 s77, s77, 49152
    buffer_load_dwordx4 v4, s[8:11], s77 offen offset:0 lds
    v_mfma_f32_16x16x32_bf16 v[224:227], v[176:179], a[152:155], v[224:227]
    v_mfma_f32_16x16x32_bf16 v[228:231], v[176:179], a[156:159], v[228:231]
    v_mfma_f32_16x16x32_bf16 v[232:235], v[180:183], a[152:155], v[232:235]
    v_mfma_f32_16x16x32_bf16 v[236:239], v[180:183], a[156:159], v[236:239]
    buffer_load_dwordx4 v5, s[8:11], s77 offen offset:1024 lds
    s_waitcnt lgkmcnt(10)
    v_mfma_f32_16x16x32_bf16 v[216:219], v[128:131], a[160:163], v[216:219]
    ds_read_b64_tr_b16 v[160:161], v19 offset:30720
    ds_read_b64_tr_b16 v[162:163], v19 offset:31488
    v_mfma_f32_16x16x32_bf16 v[220:223], v[128:131], a[164:167], v[220:223]
    ds_read_b64_tr_b16 v[164:165], v19 offset:30784
    s_waitcnt lgkmcnt(11)
    v_mfma_f32_16x16x32_bf16 v[224:227], v[132:135], a[160:163], v[224:227]
    ds_read_b64_tr_b16 v[166:167], v19 offset:31552
    ds_read_b64_tr_b16 v[168:169], v19 offset:30848
    v_mfma_f32_16x16x32_bf16 v[228:231], v[132:135], a[164:167], v[228:231]
    ds_read_b64_tr_b16 v[170:171], v19 offset:31616
    ds_read_b64_tr_b16 v[172:173], v20 offset:30720
    s_waitcnt lgkmcnt(13)
    v_mfma_f32_16x16x32_bf16 v[232:235], v[136:139], a[160:163], v[232:235]
    ds_read_b64_tr_b16 v[174:175], v20 offset:31488
    ds_read_b64_tr_b16 v[176:177], v20 offset:30784
    v_mfma_f32_16x16x32_bf16 v[236:239], v[136:139], a[164:167], v[236:239]
    buffer_load_dwordx4 v6, s[8:11], s77 offen offset:2048 lds
    ds_read_b64_tr_b16 v[178:179], v20 offset:31552
    s_waitcnt lgkmcnt(14)
    v_mfma_f32_16x16x32_bf16 v[216:219], v[140:143], a[168:171], v[216:219]
    ds_read_b64_tr_b16 v[180:181], v20 offset:30848
    ds_read_b64_tr_b16 v[182:183], v20 offset:31616
    v_mfma_f32_16x16x32_bf16 v[220:223], v[140:143], a[172:175], v[220:223]
    s_waitcnt lgkmcnt(14)
    v_mfma_f32_16x16x32_bf16 v[224:227], v[144:147], a[168:171], v[224:227]
    v_mfma_f32_16x16x32_bf16 v[228:231], v[144:147], a[172:175], v[228:231]
    s_waitcnt lgkmcnt(12)
    v_mfma_f32_16x16x32_bf16 v[232:235], v[148:151], a[168:171], v[232:235]
    s_add_u32 m0, s83, 10240
    s_xor_b32 s77, s87, 128
    buffer_load_dwordx4 v10, s[12:15], s77 offen lds
    v_mfma_f32_16x16x32_bf16 v[236:239], v[148:151], a[172:175], v[236:239]
    s_waitcnt lgkmcnt(0)
    buffer_load_dwordx4 v11, s[12:15], s77 offen offset:1024 lds
    s_waitcnt vmcnt(17)
    ds_read_b128 a[8:11], v17 offset:2048
    ds_read_b128 a[12:15], v18 offset:2048
    s_mul_i32 s77, s74, 1536
    s_add_u32 m0, s81, 0
    s_add_u32 s77, s77, s76
    buffer_load_dwordx4 v4, s[8:11], s77 offen offset:0 lds
    buffer_load_dwordx4 v5, s[8:11], s77 offen offset:1024 lds
    buffer_load_dwordx4 v6, s[8:11], s77 offen offset:2048 lds
    s_mul_i32 s77, s74, 1536
    s_add_u32 m0, s81, 3072
    s_add_u32 s77, s77, s76
    s_add_u32 s77, s77, 49152
    buffer_load_dwordx4 v4, s[8:11], s77 offen offset:0 lds
    s_waitcnt vmcnt(6)
    s_barrier
    v_mfma_f32_16x16x32_bf16 v[216:219], v[160:163], a[176:179], v[216:219]
    ds_read_b64_tr_b16 v[128:129], v19 offset:49152
    ds_read_b64_tr_b16 v[130:131], v19 offset:49920
    v_mfma_f32_16x16x32_bf16 v[220:223], v[160:163], a[180:183], v[220:223]
    buffer_load_dwordx4 v5, s[8:11], s77 offen offset:1024 lds
    ds_read_b64_tr_b16 v[132:133], v19 offset:49216
    v_mfma_f32_16x16x32_bf16 v[224:227], v[164:167], a[176:179], v[224:227]
    ds_read_b64_tr_b16 v[134:135], v19 offset:49984
    ds_read_b64_tr_b16 v[136:137], v19 offset:49280
    v_mfma_f32_16x16x32_bf16 v[228:231], v[164:167], a[180:183], v[228:231]
    ds_read_b64_tr_b16 v[138:139], v19 offset:50048
    ds_read_b64_tr_b16 v[140:141], v20 offset:49152
    v_mfma_f32_16x16x32_bf16 v[232:235], v[168:171], a[176:179], v[232:235]
    ds_read_b64_tr_b16 v[142:143], v20 offset:49920
    ds_read_b64_tr_b16 v[144:145], v20 offset:49216
    v_mfma_f32_16x16x32_bf16 v[236:239], v[168:171], a[180:183], v[236:239]
    buffer_load_dwordx4 v6, s[8:11], s77 offen offset:2048 lds
    ds_read_b64_tr_b16 v[146:147], v20 offset:49984
    v_mfma_f32_16x16x32_bf16 v[216:219], v[172:175], a[184:187], v[216:219]
    ds_read_b64_tr_b16 v[148:149], v20 offset:49280
    ds_read_b64_tr_b16 v[150:151], v20 offset:50048
    v_mfma_f32_16x16x32_bf16 v[220:223], v[172:175], a[188:191], v[220:223]
    v_bfe_u32 v40, v1, 2, 2
    v_lshl_add_u32 v40, v251, 3, v40
    v_mfma_f32_16x16x32_bf16 v[224:227], v[176:179], a[184:187], v[224:227]
    v_lshlrev_b32 v40, 5, v40
    v_and_b32 v41, 3, v1
    v_mfma_f32_16x16x32_bf16 v[228:231], v[176:179], a[188:191], v[228:231]
    s_add_u32 m0, s83, 0
    s_xor_b32 s77, s88, 128
    buffer_load_dwordx4 v10, s[12:15], s77 offen lds
    v_lshl_add_u32 v40, v41, 3, v40
    s_add_u32 s78, s100, 131072
    v_mfma_f32_16x16x32_bf16 v[232:235], v[180:183], a[184:187], v[232:235]
    v_add_u32 v40, s78, v40
    ds_read_b64_tr_b16 v[44:45], v40
    v_mfma_f32_16x16x32_bf16 v[236:239], v[180:183], a[188:191], v[236:239]
    ds_read_b64_tr_b16 v[46:47], v40 offset:128
    s_waitcnt lgkmcnt(12)
    v_mfma_f32_16x16x32_bf16 v[216:219], v[128:131], a[192:195], v[216:219]
    ds_read_b64_tr_b16 v[160:161], v19 offset:55296
    ds_read_b64_tr_b16 v[162:163], v19 offset:56064
    v_mfma_f32_16x16x32_bf16 v[220:223], v[128:131], a[196:199], v[220:223]
    ds_read_b64_tr_b16 v[164:165], v19 offset:55360
    s_waitcnt lgkmcnt(13)
    v_mfma_f32_16x16x32_bf16 v[224:227], v[132:135], a[192:195], v[224:227]
    ds_read_b64_tr_b16 v[166:167], v19 offset:56128
    ds_read_b64_tr_b16 v[168:169], v19 offset:55424
    v_mfma_f32_16x16x32_bf16 v[228:231], v[132:135], a[196:199], v[228:231]
    ds_read_b64_tr_b16 v[170:171], v19 offset:56192
    ds_read_b64_tr_b16 v[172:173], v20 offset:55296
    s_waitcnt lgkmcnt(15)
    v_mfma_f32_16x16x32_bf16 v[232:235], v[136:139], a[192:195], v[232:235]
    ds_read_b64_tr_b16 v[174:175], v20 offset:56064
    ds_read_b64_tr_b16 v[176:177], v20 offset:55360
    v_mfma_f32_16x16x32_bf16 v[236:239], v[136:139], a[196:199], v[236:239]
    buffer_load_dwordx4 v11, s[12:15], s77 offen offset:1024 lds
    ds_read_b64_tr_b16 v[178:179], v20 offset:56128
    s_waitcnt lgkmcnt(15)
    v_mfma_f32_16x16x32_bf16 v[216:219], v[140:143], a[200:203], v[216:219]
    ds_read_b64_tr_b16 v[180:181], v20 offset:55424
    ds_read_b64_tr_b16 v[182:183], v20 offset:56192
    v_mfma_f32_16x16x32_bf16 v[220:223], v[140:143], a[204:207], v[220:223]
    buffer_load_dwordx4 v[64:67], v12, s[20:23], s95 offen offset:0 sc1
    buffer_load_dwordx4 v[68:71], v12, s[20:23], s95 offen offset:1024 sc1
    s_waitcnt lgkmcnt(15)
    v_mfma_f32_16x16x32_bf16 v[224:227], v[144:147], a[200:203], v[224:227]
    buffer_load_dwordx4 v[72:75], v12, s[20:23], s96 offen offset:0 sc1
    buffer_load_dwordx4 v[76:79], v12, s[20:23], s96 offen offset:1024 sc1
    v_mfma_f32_16x16x32_bf16 v[228:231], v[144:147], a[204:207], v[228:231]
    s_waitcnt lgkmcnt(14)
    v_mfma_f32_16x16x32_bf16 v[232:235], v[148:151], a[200:203], v[232:235]
    v_mfma_f32_16x16x32_bf16 v[236:239], v[148:151], a[204:207], v[236:239]
    s_waitcnt lgkmcnt(0)
    ds_read_b128 a[16:19], v17 offset:4096
    ds_read_b128 a[20:23], v18 offset:4096
    s_add_u32 m0, s82, 24576
    s_nop 0
    buffer_load_dwordx4 v7, s[16:19], s70 offen offset:0 lds
    buffer_load_dwordx4 v8, s[16:19], s70 offen offset:1024 lds
    buffer_load_dwordx4 v9, s[16:19], s70 offen offset:2048 lds
    s_add_u32 m0, s82, 36864
    s_nop 0
    buffer_load_dwordx4 v7, s[16:19], s71 offen offset:0 lds
    buffer_load_dwordx4 v8, s[16:19], s71 offen offset:1024 lds
    s_waitcnt vmcnt(11)
    s_barrier
    buffer_load_dwordx4 v9, s[16:19], s71 offen offset:2048 lds
    v_mfma_f32_16x16x32_bf16 v[216:219], v[160:163], a[208:211], v[216:219]
    ds_read_b64_tr_b16 v[128:129], v19 offset:0
    ds_read_b64_tr_b16 v[130:131], v19 offset:768
    v_mfma_f32_16x16x32_bf16 v[220:223], v[160:163], a[212:215], v[220:223]
    s_add_u32 m0, s83, 2048
    s_xor_b32 s77, s89, 128
    buffer_load_dwordx4 v10, s[12:15], s77 offen lds
    ds_read_b64_tr_b16 v[132:133], v19 offset:64
    v_mfma_f32_16x16x32_bf16 v[224:227], v[164:167], a[208:211], v[224:227]
    ds_read_b64_tr_b16 v[134:135], v19 offset:832
    ds_read_b64_tr_b16 v[136:137], v19 offset:128
    v_mfma_f32_16x16x32_bf16 v[228:231], v[164:167], a[212:215], v[228:231]
    ds_read_b64_tr_b16 v[138:139], v19 offset:896
    ds_read_b64_tr_b16 v[140:141], v20 offset:0
    v_mfma_f32_16x16x32_bf16 v[232:235], v[168:171], a[208:211], v[232:235]
    ds_read_b64_tr_b16 v[142:143], v20 offset:768
    ds_read_b64_tr_b16 v[144:145], v20 offset:64
    v_mfma_f32_16x16x32_bf16 v[236:239], v[168:171], a[212:215], v[236:239]
    ds_read_b64_tr_b16 v[146:147], v20 offset:832
    v_mfma_f32_16x16x32_bf16 v[216:219], v[172:175], a[216:219], v[216:219]
    ds_read_b64_tr_b16 v[148:149], v20 offset:128
    ds_read_b64_tr_b16 v[150:151], v20 offset:896
    v_mfma_f32_16x16x32_bf16 v[220:223], v[172:175], a[220:223], v[220:223]
    buffer_load_dwordx4 v11, s[12:15], s77 offen offset:1024 lds
    buffer_store_dwordx4 v[44:47], v12, s[20:23], s97 offen sc1
    s_lshl_b32 s78, s65, 1
    s_add_u32 s78, s78, s94
    s_lshl_b32 s78, s78, 12
    s_add_u32 s97, s78, 786432
    v_mfma_f32_16x16x32_bf16 v[224:227], v[176:179], a[216:219], v[224:227]
    v_mfma_f32_16x16x32_bf16 v[228:231], v[176:179], a[220:223], v[228:231]
    v_mfma_f32_16x16x32_bf16 v[232:235], v[180:183], a[216:219], v[232:235]
    v_mfma_f32_16x16x32_bf16 v[236:239], v[180:183], a[220:223], v[236:239]
    s_waitcnt lgkmcnt(10)
    v_mfma_f32_16x16x32_bf16 v[216:219], v[128:131], a[224:227], v[216:219]
    ds_read_b64_tr_b16 v[160:161], v19 offset:6144
    ds_read_b64_tr_b16 v[162:163], v19 offset:6912
    v_mfma_f32_16x16x32_bf16 v[220:223], v[128:131], a[228:231], v[220:223]
    ds_read_b64_tr_b16 v[164:165], v19 offset:6208
    s_waitcnt lgkmcnt(11)
    v_mfma_f32_16x16x32_bf16 v[224:227], v[132:135], a[224:227], v[224:227]
    ds_read_b64_tr_b16 v[166:167], v19 offset:6976
    ds_read_b64_tr_b16 v[168:169], v19 offset:6272
    v_mfma_f32_16x16x32_bf16 v[228:231], v[132:135], a[228:231], v[228:231]
    ds_read_b64_tr_b16 v[170:171], v19 offset:7040
    ds_read_b64_tr_b16 v[172:173], v20 offset:6144
    s_waitcnt lgkmcnt(13)
    v_mfma_f32_16x16x32_bf16 v[232:235], v[136:139], a[224:227], v[232:235]
    ds_read_b64_tr_b16 v[174:175], v20 offset:6912
    ds_read_b64_tr_b16 v[176:177], v20 offset:6208
    v_mfma_f32_16x16x32_bf16 v[236:239], v[136:139], a[228:231], v[236:239]
    ds_read_b64_tr_b16 v[178:179], v20 offset:6976
    s_waitcnt lgkmcnt(14)
    v_mfma_f32_16x16x32_bf16 v[216:219], v[140:143], a[232:235], v[216:219]
    ds_read_b64_tr_b16 v[180:181], v20 offset:6272
    ds_read_b64_tr_b16 v[182:183], v20 offset:7040
    v_mfma_f32_16x16x32_bf16 v[220:223], v[140:143], a[236:239], v[220:223]
    ds_read_b128 a[24:27], v17 offset:6144
    ds_read_b128 a[28:31], v18 offset:6144
    s_waitcnt lgkmcnt(15)
    v_mfma_f32_16x16x32_bf16 v[224:227], v[144:147], a[232:235], v[224:227]
    s_add_u32 m0, s83, 4096
    s_xor_b32 s77, s86, 256
    buffer_load_dwordx4 v10, s[12:15], s77 offen lds
    v_mfma_f32_16x16x32_bf16 v[228:231], v[144:147], a[236:239], v[228:231]
    buffer_load_dwordx4 v11, s[12:15], s77 offen offset:1024 lds
    s_waitcnt lgkmcnt(14)
    v_mfma_f32_16x16x32_bf16 v[232:235], v[148:151], a[232:235], v[232:235]
    v_mfma_f32_16x16x32_bf16 v[236:239], v[148:151], a[236:239], v[236:239]
    ds_read_b128 a[32:35], v17 offset:8192
    ds_read_b128 a[36:39], v18 offset:8192
    s_waitcnt lgkmcnt(0)
    s_barrier
    s_add_u32 m0, s82, 49152
    s_nop 0
    buffer_load_dwordx4 v7, s[16:19], s72 offen offset:0 lds
    v_mfma_f32_16x16x32_bf16 v[216:219], v[160:163], a[240:243], v[216:219]
    buffer_load_dwordx4 v8, s[16:19], s72 offen offset:1024 lds
    v_mfma_f32_16x16x32_bf16 v[220:223], v[160:163], a[244:247], v[220:223]
    v_mfma_f32_16x16x32_bf16 v[224:227], v[164:167], a[240:243], v[224:227]
    buffer_load_dwordx4 v9, s[16:19], s72 offen offset:2048 lds
    v_mfma_f32_16x16x32_bf16 v[228:231], v[164:167], a[244:247], v[228:231]
    v_mfma_f32_16x16x32_bf16 v[232:235], v[168:171], a[240:243], v[232:235]
    v_mfma_f32_16x16x32_bf16 v[236:239], v[168:171], a[244:247], v[236:239]
    v_mfma_f32_16x16x32_bf16 v[216:219], v[172:175], a[248:251], v[216:219]
    s_add_u32 m0, s82, 61440
    s_nop 0
    buffer_load_dwordx4 v7, s[16:19], s73 offen offset:0 lds
    v_mfma_f32_16x16x32_bf16 v[220:223], v[172:175], a[252:255], v[220:223]
    v_mfma_f32_16x16x32_bf16 v[224:227], v[176:179], a[248:251], v[224:227]
    v_mfma_f32_16x16x32_bf16 v[228:231], v[176:179], a[252:255], v[228:231]
    v_mfma_f32_16x16x32_bf16 v[232:235], v[180:183], a[248:251], v[232:235]
    buffer_load_dwordx4 v8, s[16:19], s73 offen offset:1024 lds
    v_mfma_f32_16x16x32_bf16 v[236:239], v[180:183], a[252:255], v[236:239]
    s_waitcnt vmcnt(16)
L_chk_1:
    v_min3_u32 v46, v65, v67, v69
    v_max3_u32 v47, v65, v67, v69
    v_min3_u32 v46, v46, v71, v73
    v_max3_u32 v47, v47, v71, v73
    v_min3_u32 v46, v46, v75, v77
    v_max3_u32 v47, v47, v75, v77
    v_min_u32 v46, v46, v79
    v_max_u32 v47, v47, v79
    v_cmp_ne_u32 vcc, s68, v46
    v_cmp_ne_u32 s[62:63], s68, v47
    s_nop 0
    s_or_b64 vcc, vcc, s[62:63]
    s_cbranch_vccz L_ok_2
    s_cmp_eq_u32 s69, 0
    s_cbranch_scc1 L_ok_2
    s_sub_u32 s69, s69, 1
    buffer_load_dwordx4 v[64:67], v12, s[20:23], s95 offen offset:0 sc1
    buffer_load_dwordx4 v[68:71], v12, s[20:23], s95 offen offset:1024 sc1
    buffer_load_dwordx4 v[72:75], v12, s[20:23], s96 offen offset:0 sc1
    buffer_load_dwordx4 v[76:79], v12, s[20:23], s96 offen offset:1024 sc1
    s_waitcnt vmcnt(0)
    s_branch L_chk_1
L_ok_2:
    buffer_load_dwordx4 v9, s[16:19], s73 offen offset:2048 lds
    v_add_f32 v40, v64, v68
    v_add_f32 v42, v66, v70
    v_add_f32 v44, v72, v76
    v_add_f32 v46, v74, v78
    v_mov_b32 v41, v40
    v_mov_b32 v43, v42
    v_mov_b32 v45, v44
    v_mov_b32 v47, v46
    s_add_u32 m0, s83, 6144
    s_xor_b32 s77, s87, 256
    buffer_load_dwordx4 v10, s[12:15], s77 offen lds
    v_permlane32_swap_b32 v41, v40
    v_permlane32_swap_b32 v43, v42
    v_permlane32_swap_b32 v45, v44
    v_permlane32_swap_b32 v47, v46
    v_add_f32 v40, v40, v41
    v_add_f32 v42, v42, v43
    v_add_f32 v44, v44, v45
    v_add_f32 v46, v46, v47
    v_mov_b32 v41, v40
    buffer_load_dwordx4 v11, s[12:15], s77 offen offset:1024 lds
    v_mov_b32 v43, v42
    v_mov_b32 v45, v44
    v_mov_b32 v47, v46
    v_permlane16_swap_b32 v41, v40
    v_permlane16_swap_b32 v43, v42
    v_permlane16_swap_b32 v45, v44
    v_permlane16_swap_b32 v47, v46
    v_add_f32 v40, v40, v41
    v_add_f32 v42, v42, v43
    v_add_f32 v44, v44, v45
    v_add_f32 v46, v46, v47
    v_mul_f32 v40, 0x3aaaaaab, v40
    ds_read_b128 a[40:43], v17 offset:10240
    ds_read_b128 a[44:47], v18 offset:10240
    v_mul_f32 v44, 0x3aaaaaab, v44
    s_add_u32 m0, s83, 8192
    s_xor_b32 s77, s88, 256
    buffer_load_dwordx4 v10, s[12:15], s77 offen lds
    v_mul_f32 v42, 0x3aaaaaab, v42
    v_mul_f32 v46, 0x3aaaaaab, v46
    v_fma_f32 v42, -v40, v40, v42
    v_fma_f32 v46, -v44, v44, v46
    v_max_f32 v42, 0, v42
    v_max_f32 v46, 0, v46
    v_add_f32 v42, 0x3727c5ac, v42
    buffer_load_dwordx4 v11, s[12:15], s77 offen offset:1024 lds
    v_add_f32 v46, 0x3727c5ac, v46
    v_rsq_f32 v42, v42
    v_rsq_f32 v46, v46
    v_mul_f32 v40, -v40, v42
    v_mul_f32 v44, -v44, v46
    s_mul_i32 s78, s66, 393216
    s_add_u32 s78, s78, 0x200000
    v_pk_fma_f32 v[192:193], v[192:193], v[42:43], v[40:41] op_sel_hi:[1,0,0]
    v_pk_fma_f32 v[194:195], v[194:195], v[42:43], v[40:41] op_sel_hi:[1,0,0]
    v_pk_fma_f32 v[196:197], v[196:197], v[46:47], v[44:45] op_sel_hi:[1,0,0]
    ds_read_b128 a[48:51], v17 offset:0
    ds_read_b128 a[52:55], v18 offset:0
    v_pk_fma_f32 v[198:199], v[198:199], v[46:47], v[44:45] op_sel_hi:[1,0,0]
    s_add_u32 m0, s82, 0
    s_nop 0
    buffer_load_dwordx4 v7, s[16:19], s74 offen offset:0 lds
    v_cvt_pk_bf16_f32 v160, v192, v193
    v_cvt_pk_bf16_f32 v161, v194, v195
    v_cvt_pk_bf16_f32 v162, v196, v197
    v_cvt_pk_bf16_f32 v163, v198, v199
    s_nop 0
    v_permlane16_swap_b32 v160, v162
    v_permlane16_swap_b32 v161, v163
    buffer_store_dwordx4 v[160:163], v30, s[20:23], s78 offen sc1
    s_add_u32 s78, s78, 131072
    v_pk_fma_f32 v[200:201], v[200:201], v[42:43], v[40:41] op_sel_hi:[1,0,0]
    buffer_load_dwordx4 v8, s[16:19], s74 offen offset:1024 lds
    v_pk_fma_f32 v[202:203], v[202:203], v[42:43], v[40:41] op_sel_hi:[1,0,0]
    v_pk_fma_f32 v[204:205], v[204:205], v[46:47], v[44:45] op_sel_hi:[1,0,0]
    v_pk_fma_f32 v[206:207], v[206:207], v[46:47], v[44:45] op_sel_hi:[1,0,0]
    v_cvt_pk_bf16_f32 v164, v200, v201
    v_cvt_pk_bf16_f32 v165, v202, v203
    v_cvt_pk_bf16_f32 v166, v204, v205
    v_cvt_pk_bf16_f32 v167, v206, v207
    s_nop 0
    v_permlane16_swap_b32 v164, v166
    v_permlane16_swap_b32 v165, v167
    buffer_store_dwordx4 v[164:167], v30, s[20:23], s78 offen sc1
    s_add_u32 s78, s78, 131072
    v_pk_fma_f32 v[208:209], v[208:209], v[42:43], v[40:41] op_sel_hi:[1,0,0]
    buffer_load_dwordx4 v9, s[16:19], s74 offen offset:2048 lds
    v_pk_fma_f32 v[210:211], v[210:211], v[42:43], v[40:41] op_sel_hi:[1,0,0]
    v_pk_fma_f32 v[212:213], v[212:213], v[46:47], v[44:45] op_sel_hi:[1,0,0]
    v_pk_fma_f32 v[214:215], v[214:215], v[46:47], v[44:45] op_sel_hi:[1,0,0]
    v_cvt_pk_bf16_f32 v168, v208, v209
    v_cvt_pk_bf16_f32 v169, v210, v211
    v_cvt_pk_bf16_f32 v170, v212, v213
    v_cvt_pk_bf16_f32 v171, v214, v215
    s_nop 0
    v_permlane16_swap_b32 v168, v170
    v_permlane16_swap_b32 v169, v171
    buffer_store_dwordx4 v[168:171], v30, s[20:23], s78 offen sc1
    s_mul_i32 s78, s67, 6144
    s_add_u32 s78, s78, 2048
    s_waitcnt lgkmcnt(2)
    s_add_u32 m0, s83, 10240
    s_xor_b32 s77, s89, 256
    buffer_load_dwordx4 v10, s[12:15], s77 offen lds
    v_add_u32 v15, s78, v13
    v_add_u32 v16, s78, v14
    s_lshl_b32 s95, s66, 2
    s_add_u32 s95, s95, s64
    s_lshl_b32 s95, s95, 10
    s_add_u32 s95, s95, 32768
    s_lshl_b32 s78, s65, 5
    s_add_u32 s2, s78, s95
    v_mul_f32 v29, 0xbfb8aa3b, v116
    v_exp_f32 v29, v29
    buffer_load_dwordx4 v11, s[12:15], s77 offen offset:1024 lds
    v_add_f32 v29, 1.0, v29
    v_rcp_f32 v29, v29
    s_waitcnt vmcnt(23)
    s_barrier
    ds_read_b128 v[128:131], v15 offset:22528
    s_waitcnt vmcnt(21)
    ds_read_b128 a[56:59], v17 offset:2048
    ds_read_b128 a[60:63], v18 offset:2048
    ds_read_b128 v[132:135], v15 offset:24576
    s_waitcnt lgkmcnt(4)
    s_add_u32 m0, s83, 0
    s_xor_b32 s77, s86, 384
    buffer_load_dwordx4 v10, s[12:15], s77 offen lds
    ds_read_b128 v[136:139], v15 offset:26624
    s_waitcnt lgkmcnt(4)
    v_mfma_f32_16x16x32_bf16 v[64:67], a[96:99], v[128:131], 0
    ds_read_b128 v[160:163], v16 offset:22528
    v_and_b32 v40, 1, v251
    v_mfma_f32_16x16x32_bf16 v[68:71], a[100:103], v[128:131], 0
    buffer_load_dwordx4 v11, s[12:15], s77 offen offset:1024 lds
    ds_read_b128 v[164:167], v16 offset:24576
    v_mfma_f32_16x16x32_bf16 v[88:91], a[104:107], v[128:131], 0
    ds_read_b128 v[168:171], v16 offset:26624
    v_xor_b32 v40, s64, v40
    v_mfma_f32_16x16x32_bf16 v[92:95], a[108:111], v[128:131], 0
    v_lshrrev_b32 v41, 1, v251
    v_lshl_add_u32 v40, v40, 1, v41
    s_waitcnt lgkmcnt(4)
    v_mfma_f32_16x16x32_bf16 v[72:75], a[96:99], v[132:135], 0
    v_lshrrev_b32 v41, 1, v252
    v_xor_b32 v40, v40, v41
    v_mfma_f32_16x16x32_bf16 v[76:79], a[100:103], v[132:135], 0
    v_lshlrev_b32 v40, 4, v40
    v_mfma_f32_16x16x32_bf16 v[96:99], a[104:107], v[132:135], 0
    s_waitcnt vmcnt(20)
    ds_read_b128 a[64:67], v17 offset:4096
    ds_read_b128 a[68:71], v18 offset:4096
    v_mfma_f32_16x16x32_bf16 v[100:103], a[108:111], v[132:135], 0
    s_add_u32 m0, s83, 2048
    s_xor_b32 s77, s87, 384
    buffer_load_dwordx4 v10, s[12:15], s77 offen lds
    s_waitcnt lgkmcnt(5)
    v_mfma_f32_16x16x32_bf16 v[80:83], a[96:99], v[136:139], 0
    buffer_load_dwordx4 v11, s[12:15], s77 offen offset:1024 lds
    v_mfma_f32_16x16x32_bf16 v[84:87], a[100:103], v[136:139], 0
    v_mfma_f32_16x16x32_bf16 v[104:107], a[104:107], v[136:139], 0
    v_mfma_f32_16x16x32_bf16 v[108:111], a[108:111], v[136:139], 0
    s_waitcnt vmcnt(14)
    ds_read_b128 a[72:75], v17 offset:6144
    ds_read_b128 a[76:79], v18 offset:6144
    s_waitcnt lgkmcnt(6)
    v_mfma_f32_16x16x32_bf16 v[64:67], a[112:115], v[160:163], v[64:67]
    ds_read_b128 v[128:131], v15 offset:34816
    v_lshl_add_u32 v40, v252, 7, v40
    s_mul_i32 s78, s67, 6144
    v_mfma_f32_16x16x32_bf16 v[68:71], a[116:119], v[160:163], v[68:71]
    s_waitcnt lgkmcnt(3)
    s_add_u32 m0, s83, 4096
    s_xor_b32 s77, s88, 384
    buffer_load_dwordx4 v10, s[12:15], s77 offen lds
    ds_read_b128 v[132:135], v15 offset:36864
    v_mfma_f32_16x16x32_bf16 v[88:91], a[120:123], v[160:163], v[88:91]
    ds_read_b128 v[136:139], v15 offset:38912
    v_add_u32 v21, s78, v40
    v_mfma_f32_16x16x32_bf16 v[92:95], a[124:127], v[160:163], v[92:95]
    v_xor_b32 v144, v250, v240
    v_xor_b32 v148, v250, v244
    v_mfma_f32_16x16x32_bf16 v[72:75], a[112:115], v[164:167], v[72:75]
    v_xor_b32 v152, 0x80008000, v244
    v_xor_b32 v176, 0x80008000, v240
    v_mfma_f32_16x16x32_bf16 v[76:79], a[116:119], v[164:167], v[76:79]
    buffer_load_dwordx4 v11, s[12:15], s77 offen offset:1024 lds
    v_mfma_f32_16x16x32_bf16 v[96:99], a[120:123], v[164:167], v[96:99]
    s_waitcnt vmcnt(14)
    ds_read_b128 a[80:83], v17 offset:8192
    ds_read_b128 a[84:87], v18 offset:8192
    v_mfma_f32_16x16x32_bf16 v[100:103], a[124:127], v[164:167], v[100:103]
    s_waitcnt lgkmcnt(5)
    s_add_u32 m0, s83, 6144
    s_xor_b32 s77, s89, 384
    buffer_load_dwordx4 v10, s[12:15], s77 offen lds
    v_mfma_f32_16x16x32_bf16 v[80:83], a[112:115], v[168:171], v[80:83]
    buffer_load_dwordx4 v11, s[12:15], s77 offen offset:1024 lds
    v_mfma_f32_16x16x32_bf16 v[84:87], a[116:119], v[168:171], v[84:87]
    v_mfma_f32_16x16x32_bf16 v[104:107], a[120:123], v[168:171], v[104:107]
    v_mfma_f32_16x16x32_bf16 v[108:111], a[124:127], v[168:171], v[108:111]
    s_waitcnt lgkmcnt(4)
    v_mfma_f32_16x16x32_bf16 v[64:67], a[128:131], v[128:131], v[64:67]
    ds_read_b128 v[160:163], v16 offset:34816
    v_xor_b32 v145, v250, v241
    v_mfma_f32_16x16x32_bf16 v[68:71], a[132:135], v[128:131], v[68:71]
    ds_read_b128 v[164:167], v16 offset:36864
    v_mfma_f32_16x16x32_bf16 v[88:91], a[136:139], v[128:131], v[88:91]
    ds_read_b128 v[168:171], v16 offset:38912
    v_xor_b32 v149, v250, v245
    v_mfma_f32_16x16x32_bf16 v[92:95], a[140:143], v[128:131], v[92:95]
    s_waitcnt vmcnt(10)
    v_mov_b32 v0, 0
    s_mov_b64 exec, 1
    buffer_store_dword v31, v0, s[20:23], s2 offen sc1
    s_mov_b64 exec, -1
    v_xor_b32 v153, 0x80008000, v245
    v_xor_b32 v177, 0x80008000, v241
    s_waitcnt lgkmcnt(6)
    v_mfma_f32_16x16x32_bf16 v[72:75], a[128:131], v[132:135], v[72:75]
    v_xor_b32 v146, v250, v242
    v_xor_b32 v150, v250, v246
    v_mfma_f32_16x16x32_bf16 v[76:79], a[132:135], v[132:135], v[76:79]
    v_xor_b32 v154, 0x80008000, v246
    v_mfma_f32_16x16x32_bf16 v[96:99], a[136:139], v[132:135], v[96:99]
    v_mfma_f32_16x16x32_bf16 v[100:103], a[140:143], v[132:135], v[100:103]
    s_waitcnt lgkmcnt(5)
    v_mfma_f32_16x16x32_bf16 v[80:83], a[128:131], v[136:139], v[80:83]
    v_mfma_f32_16x16x32_bf16 v[84:87], a[132:135], v[136:139], v[84:87]
    v_mfma_f32_16x16x32_bf16 v[104:107], a[136:139], v[136:139], v[104:107]
    s_waitcnt vmcnt(9)
    ds_read_b128 a[88:91], v17 offset:10240
    ds_read_b128 a[92:95], v18 offset:10240
    v_mfma_f32_16x16x32_bf16 v[108:111], a[140:143], v[136:139], v[108:111]
    s_waitcnt lgkmcnt(5)
    s_add_u32 m0, s83, 8192
    s_xor_b32 s77, s86, 512
    s_xor_b32 s77, s77, s61
    buffer_load_dwordx4 v10, s[12:15], s77 offen lds
    s_barrier
    s_waitcnt lgkmcnt(4)
    v_mfma_f32_16x16x32_bf16 v[64:67], a[144:147], v[160:163], v[64:67]
    ds_read_b128 v[128:131], v15 offset:47104
    v_xor_b32 v178, 0x80008000, v242
    v_mfma_f32_16x16x32_bf16 v[68:71], a[148:151], v[160:163], v[68:71]
    buffer_load_dwordx4 v11, s[12:15], s77 offen offset:1024 lds
    ds_read_b128 v[132:135], v15 offset:49152
    v_mfma_f32_16x16x32_bf16 v[88:91], a[152:155], v[160:163], v[88:91]
    ds_read_b128 v[136:139], v15 offset:51200
    v_xor_b32 v147, v250, v243
    v_mfma_f32_16x16x32_bf16 v[92:95], a[156:159], v[160:163], v[92:95]
    v_xor_b32 v151, v250, v247
    v_xor_b32 v155, 0x80008000, v247
    s_waitcnt lgkmcnt(6)
    v_mfma_f32_16x16x32_bf16 v[72:75], a[144:147], v[164:167], v[72:75]
    v_xor_b32 v179, 0x80008000, v243
    v_xor_b32 v156, 0x80008000, v148
    v_mfma_f32_16x16x32_bf16 v[76:79], a[148:151], v[164:167], v[76:79]
    v_xor_b32 v180, 0x80008000, v144
    v_mfma_f32_16x16x32_bf16 v[96:99], a[152:155], v[164:167], v[96:99]
    s_waitcnt vmcnt(9)
    ds_read_b128 a[96:99], v17 offset:0
    ds_read_b128 a[100:103], v18 offset:0
    v_mfma_f32_16x16x32_bf16 v[100:103], a[156:159], v[164:167], v[100:103]
    s_waitcnt lgkmcnt(5)
    s_add_u32 m0, s83, 10240
    s_xor_b32 s77, s87, 512
    s_xor_b32 s77, s77, s61
    buffer_load_dwordx4 v10, s[12:15], s77 offen lds
    v_mfma_f32_16x16x32_bf16 v[80:83], a[144:147], v[168:171], v[80:83]
    v_mfma_f32_16x16x32_bf16 v[84:87], a[148:151], v[168:171], v[84:87]
    v_mfma_f32_16x16x32_bf16 v[104:107], a[152:155], v[168:171], v[104:107]
    buffer_load_dwordx4 v11, s[12:15], s77 offen offset:1024 lds
    v_mfma_f32_16x16x32_bf16 v[108:111], a[156:159], v[168:171], v[108:111]
    s_waitcnt lgkmcnt(4)
    v_mfma_f32_16x16x32_bf16 v[64:67], a[160:163], v[128:131], v[64:67]
    ds_read_b128 v[160:163], v16 offset:47104
    v_xor_b32 v157, 0x80008000, v149
    v_mfma_f32_16x16x32_bf16 v[68:71], a[164:167], v[128:131], v[68:71]
    ds_read_b128 v[164:167], v16 offset:49152
    v_mfma_f32_16x16x32_bf16 v[88:91], a[168:171], v[128:131], v[88:91]
    ds_read_b128 v[168:171], v16 offset:51200
    v_xor_b32 v181, 0x80008000, v145
    v_mfma_f32_16x16x32_bf16 v[92:95], a[172:175], v[128:131], v[92:95]
    v_xor_b32 v158, 0x80008000, v150
    v_xor_b32 v182, 0x80008000, v146
    s_waitcnt lgkmcnt(6)
    v_mfma_f32_16x16x32_bf16 v[72:75], a[160:163], v[132:135], v[72:75]
    v_xor_b32 v159, 0x80008000, v151
    v_xor_b32 v183, 0x80008000, v147
    s_mul_i32 s96, s64, 5248
    v_mfma_f32_16x16x32_bf16 v[76:79], a[164:167], v[132:135], v[76:79]
    s_waitcnt vmcnt(9)
    ds_read_b128 a[104:107], v17 offset:2048
    ds_read_b128 a[108:111], v18 offset:2048
    v_mfma_f32_16x16x32_bf16 v[96:99], a[168:171], v[132:135], v[96:99]
    s_waitcnt lgkmcnt(5)
    s_add_u32 m0, s83, 0
    s_xor_b32 s77, s88, 512
    s_xor_b32 s77, s77, s61
    buffer_load_dwordx4 v10, s[12:15], s77 offen lds
    v_mfma_f32_16x16x32_bf16 v[100:103], a[172:175], v[132:135], v[100:103]
    v_mfma_f32_16x16x32_bf16 v[80:83], a[160:163], v[136:139], v[80:83]
    v_mfma_f32_16x16x32_bf16 v[84:87], a[164:167], v[136:139], v[84:87]
    buffer_load_dwordx4 v11, s[12:15], s77 offen offset:1024 lds
    v_mfma_f32_16x16x32_bf16 v[104:107], a[168:171], v[136:139], v[104:107]
    v_mfma_f32_16x16x32_bf16 v[108:111], a[172:175], v[136:139], v[108:111]
    s_waitcnt lgkmcnt(4)
    v_mfma_f32_16x16x32_bf16 v[64:67], a[176:179], v[160:163], v[64:67]
    ds_read_b128 v[128:131], v15 offset:59392
    s_add_u32 s96, s96, 139264
    v_and_b32 v40, 7, v252
    v_mfma_f32_16x16x32_bf16 v[68:71], a[180:183], v[160:163], v[68:71]
    ds_read_b128 v[132:135], v15 offset:61440
    v_mfma_f32_16x16x32_bf16 v[88:91], a[184:187], v[160:163], v[88:91]
    ds_read_b128 v[136:139], v15 offset:63488
    v_mul_u32_u24 v40, 656, v40
    v_mfma_f32_16x16x32_bf16 v[92:95], a[188:191], v[160:163], v[92:95]
    v_lshrrev_b32 v41, 3, v252
    v_mul_u32_u24 v41, 160, v41
    s_waitcnt lgkmcnt(6)
    v_mfma_f32_16x16x32_bf16 v[72:75], a[176:179], v[164:167], v[72:75]
    v_lshl_add_u32 v40, v251, 4, v40
    v_add3_u32 v19, s96, v40, v41
    v_mfma_f32_16x16x32_bf16 v[76:79], a[180:183], v[164:167], v[76:79]
    s_waitcnt vmcnt(9)
    ds_read_b128 a[112:115], v17 offset:4096
    ds_read_b128 a[116:119], v18 offset:4096
    v_mfma_f32_16x16x32_bf16 v[96:99], a[184:187], v[164:167], v[96:99]
    s_waitcnt lgkmcnt(5)
    s_add_u32 m0, s83, 2048
    s_xor_b32 s77, s89, 512
    s_xor_b32 s77, s77, s61
    buffer_load_dwordx4 v10, s[12:15], s77 offen lds
    v_mfma_f32_16x16x32_bf16 v[100:103], a[188:191], v[164:167], v[100:103]
    v_mfma_f32_16x16x32_bf16 v[80:83], a[176:179], v[168:171], v[80:83]
    v_mfma_f32_16x16x32_bf16 v[84:87], a[180:183], v[168:171], v[84:87]
    buffer_load_dwordx4 v11, s[12:15], s77 offen offset:1024 lds
    v_mfma_f32_16x16x32_bf16 v[104:107], a[184:187], v[168:171], v[104:107]
    v_mfma_f32_16x16x32_bf16 v[108:111], a[188:191], v[168:171], v[108:111]
    s_waitcnt lgkmcnt(4)
    v_mfma_f32_16x16x32_bf16 v[64:67], a[192:195], v[128:131], v[64:67]
    ds_read_b128 v[160:163], v16 offset:59392
    v_lshrrev_b32 v41, 1, v251
    v_mfma_f32_16x16x32_bf16 v[68:71], a[196:199], v[128:131], v[68:71]
    ds_read_b128 v[164:167], v16 offset:61440
    v_mfma_f32_16x16x32_bf16 v[88:91], a[200:203], v[128:131], v[88:91]
    ds_read_b128 v[168:171], v16 offset:63488
    v_mul_u32_u24 v41, 160, v41
    v_mfma_f32_16x16x32_bf16 v[92:95], a[204:207], v[128:131], v[92:95]
    v_add_u32 v38, v19, v41
    v_mul_u32_u24 v40, 1639, v1
    s_waitcnt lgkmcnt(6)
    v_mfma_f32_16x16x32_bf16 v[72:75], a[192:195], v[132:135], v[72:75]
    v_add_u32 v42, s96, v12
    v_lshrrev_b32 v41, 16, v40
    v_mfma_f32_16x16x32_bf16 v[76:79], a[196:199], v[132:135], v[76:79]
    v_lshl_add_u32 v112, v41, 4, v42
    v_mfma_f32_16x16x32_bf16 v[96:99], a[200:203], v[132:135], v[96:99]
    s_waitcnt vmcnt(9)
    ds_read_b128 a[120:123], v17 offset:6144
    ds_read_b128 a[124:127], v18 offset:6144
    v_mfma_f32_16x16x32_bf16 v[100:103], a[204:207], v[132:135], v[100:103]
    s_waitcnt lgkmcnt(5)
    s_add_u32 m0, s83, 4096
    s_xor_b32 s77, s86, 640
    s_xor_b32 s77, s77, s61
    buffer_load_dwordx4 v10, s[12:15], s77 offen lds
    v_mfma_f32_16x16x32_bf16 v[80:83], a[192:195], v[136:139], v[80:83]
    v_mfma_f32_16x16x32_bf16 v[84:87], a[196:199], v[136:139], v[84:87]
    buffer_load_dwordx4 v11, s[12:15], s77 offen offset:1024 lds
    v_mfma_f32_16x16x32_bf16 v[104:107], a[200:203], v[136:139], v[104:107]
    v_mfma_f32_16x16x32_bf16 v[108:111], a[204:207], v[136:139], v[108:111]
    s_waitcnt lgkmcnt(4)
    v_mfma_f32_16x16x32_bf16 v[64:67], a[208:211], v[160:163], v[64:67]
    v_subrev_u32 v15, 2048, v15
    v_add_u32 v40, 104896, v40
    v_mfma_f32_16x16x32_bf16 v[68:71], a[212:215], v[160:163], v[68:71]
    ds_read_b128 v[128:131], v15 offset:0
    v_mfma_f32_16x16x32_bf16 v[88:91], a[216:219], v[160:163], v[88:91]
    ds_read_b128 v[132:135], v15 offset:2048
    v_lshrrev_b32 v41, 16, v40
    v_mfma_f32_16x16x32_bf16 v[92:95], a[220:223], v[160:163], v[92:95]
    ds_read_b128 v[136:139], v15 offset:4096
    v_lshl_add_u32 v113, v41, 4, v42
    s_waitcnt lgkmcnt(6)
    v_mfma_f32_16x16x32_bf16 v[72:75], a[208:211], v[164:167], v[72:75]
    v_add_u32 v40, 104896, v40
    v_lshrrev_b32 v41, 16, v40
    v_mfma_f32_16x16x32_bf16 v[76:79], a[212:215], v[164:167], v[76:79]
    v_lshl_add_u32 v114, v41, 4, v42
    v_mfma_f32_16x16x32_bf16 v[96:99], a[216:219], v[164:167], v[96:99]
    v_add_u32 v40, 104896, v40
    v_mfma_f32_16x16x32_bf16 v[100:103], a[220:223], v[164:167], v[100:103]
    s_waitcnt vmcnt(8)
    ds_read_b128 a[128:131], v17 offset:8192
    ds_read_b128 a[132:135], v18 offset:8192
    s_waitcnt lgkmcnt(7)
    v_mfma_f32_16x16x32_bf16 v[80:83], a[208:211], v[168:171], v[80:83]
    s_waitcnt lgkmcnt(5)
    s_add_u32 m0, s83, 6144
    s_xor_b32 s77, s87, 640
    s_xor_b32 s77, s77, s61
    buffer_load_dwordx4 v10, s[12:15], s77 offen lds
    v_mfma_f32_16x16x32_bf16 v[84:87], a[212:215], v[168:171], v[84:87]
    v_mfma_f32_16x16x32_bf16 v[104:107], a[216:219], v[168:171], v[104:107]
    buffer_load_dwordx4 v11, s[12:15], s77 offen offset:1024 lds
    v_mfma_f32_16x16x32_bf16 v[108:111], a[220:223], v[168:171], v[108:111]
    s_waitcnt lgkmcnt(4)
    v_mfma_f32_16x16x32_bf16 v[64:67], a[224:227], v[128:131], v[64:67]
    v_subrev_u32 v16, 2048, v16
    v_lshrrev_b32 v41, 16, v40
    v_mfma_f32_16x16x32_bf16 v[68:71], a[228:231], v[128:131], v[68:71]
    ds_read_b128 v[160:163], v16 offset:0
    v_mfma_f32_16x16x32_bf16 v[88:91], a[232:235], v[128:131], v[88:91]
    ds_read_b128 v[164:167], v16 offset:2048
    v_lshl_add_u32 v115, v41, 4, v42
    v_mfma_f32_16x16x32_bf16 v[92:95], a[236:239], v[128:131], v[92:95]
    ds_read_b128 v[168:171], v16 offset:4096
    v_add_u32 v40, 104896, v40
    s_waitcnt lgkmcnt(6)
    v_mfma_f32_16x16x32_bf16 v[72:75], a[224:227], v[132:135], v[72:75]
    v_lshrrev_b32 v41, 16, v40
    v_lshl_add_u32 v120, v41, 4, v42
    s_mul_i32 s78, s64, 1310720
    s_mul_i32 s79, s65, 320
    v_mfma_f32_16x16x32_bf16 v[76:79], a[228:231], v[132:135], v[76:79]
    s_waitcnt vmcnt(8)
    ds_read_b128 a[136:139], v17 offset:10240
    ds_read_b128 a[140:143], v18 offset:10240
    v_mfma_f32_16x16x32_bf16 v[96:99], a[232:235], v[132:135], v[96:99]
    s_waitcnt lgkmcnt(5)
    s_add_u32 m0, s83, 8192
    s_xor_b32 s77, s88, 640
    s_xor_b32 s77, s77, s61
    buffer_load_dwordx4 v10, s[12:15], s77 offen lds
    v_mfma_f32_16x16x32_bf16 v[100:103], a[236:239], v[132:135], v[100:103]
    v_mfma_f32_16x16x32_bf16 v[80:83], a[224:227], v[136:139], v[80:83]
    v_mfma_f32_16x16x32_bf16 v[84:87], a[228:231], v[136:139], v[84:87]
    buffer_load_dwordx4 v11, s[12:15], s77 offen offset:1024 lds
    v_mfma_f32_16x16x32_bf16 v[104:107], a[232:235], v[136:139], v[104:107]
    v_mfma_f32_16x16x32_bf16 v[108:111], a[236:239], v[136:139], v[108:111]
    s_waitcnt lgkmcnt(4)
    v_mfma_f32_16x16x32_bf16 v[64:67], a[240:243], v[160:163], v[64:67]
    s_add_u32 s78, s78, s79
    s_mul_i32 s79, s66, 10240
    s_add_u32 s78, s78, s79
    s_add_u32 s96, s78, 0x800000
    s_add_u32 s60, s96, 4096
    v_and_b32 v22, 31, v1
    v_lshlrev_b32 v22, 5, v22
    v_mfma_f32_16x16x32_bf16 v[68:71], a[244:247], v[160:163], v[68:71]
    v_mfma_f32_16x16x32_bf16 v[88:91], a[248:251], v[160:163], v[88:91]
    s_waitcnt vmcnt(8)
    ds_read_b128 a[144:147], v17 offset:0
    ds_read_b128 a[148:151], v18 offset:0
    v_mfma_f32_16x16x32_bf16 v[92:95], a[252:255], v[160:163], v[92:95]
    s_waitcnt lgkmcnt(2)
    s_add_u32 m0, s83, 10240
    s_xor_b32 s77, s89, 640
    s_xor_b32 s77, s77, s61
    buffer_load_dwordx4 v10, s[12:15], s77 offen lds
    v_mfma_f32_16x16x32_bf16 v[72:75], a[240:243], v[164:167], v[72:75]
    v_mfma_f32_16x16x32_bf16 v[76:79], a[244:247], v[164:167], v[76:79]
    v_mfma_f32_16x16x32_bf16 v[96:99], a[248:251], v[164:167], v[96:99]
    v_mfma_f32_16x16x32_bf16 v[100:103], a[252:255], v[164:167], v[100:103]
    buffer_load_dwordx4 v11, s[12:15], s77 offen offset:1024 lds
    v_mfma_f32_16x16x32_bf16 v[80:83], a[240:243], v[168:171], v[80:83]
    v_mfma_f32_16x16x32_bf16 v[84:87], a[244:247], v[168:171], v[84:87]
    v_mfma_f32_16x16x32_bf16 v[104:107], a[248:251], v[168:171], v[104:107]
    v_mfma_f32_16x16x32_bf16 v[108:111], a[252:255], v[168:171], v[108:111]
    s_getpc_b64 s[40:41]
L_cq1:
    s_mov_b32 s42, L_code_end - L_cq1
    s_mov_b32 s43, 0x20000
    s_and_b32 s78, s65, 7
    s_lshl_b32 s78, s78, 2
    s_add_u32 s78, s78, s64
    s_lshl_b32 s78, s78, 8
    s_add_u32 s78, s78, 2048
    v_and_b32 v0, 128, v12
    buffer_load_dword v51, v0, s[40:43], s78 offen
    s_waitcnt vmcnt(9)
    ds_read_b128 a[152:155], v17 offset:2048
    ds_read_b128 a[156:159], v18 offset:2048
    s_mul_i32 s101, s64, 24576
    s_waitcnt lgkmcnt(2)
    s_add_u32 m0, s83, 0
    s_xor_b32 s77, s86, 768
    s_xor_b32 s77, s77, s61
    buffer_load_dwordx4 v10, s[12:15], s77 offen lds
    buffer_load_dword v48, v22, s[20:23], s95 offen sc1
    v_pk_mul_f32 v[64:65], v[64:65], v[252:253] op_sel:[0,1] op_sel_hi:[1,1]
    v_pk_mul_f32 v[66:67], v[66:67], v[252:253] op_sel:[0,1] op_sel_hi:[1,1]
    v_pk_mul_f32 v[68:69], v[68:69], v[252:253] op_sel:[0,1] op_sel_hi:[1,1]
    v_pk_mul_f32 v[70:71], v[70:71], v[252:253] op_sel:[0,1] op_sel_hi:[1,1]
    v_pk_fma_f32 v[64:65], v[88:89], v[254:255], v[64:65] op_sel_hi:[1,0,1]
    buffer_load_dwordx4 v11, s[12:15], s77 offen offset:1024 lds
    v_pk_fma_f32 v[66:67], v[90:91], v[254:255], v[66:67] op_sel_hi:[1,0,1]
    v_pk_fma_f32 v[68:69], v[92:93], v[254:255], v[68:69] op_sel_hi:[1,0,1]
    v_pk_fma_f32 v[70:71], v[94:95], v[254:255], v[70:71] op_sel_hi:[1,0,1]
    v_cvt_pk_bf16_f32 v192, v64, v65
    v_cvt_pk_bf16_f32 v193, v66, v67
    v_cvt_pk_bf16_f32 v194, v68, v69
    v_cvt_pk_bf16_f32 v195, v70, v71
    s_nop 0
    v_permlane16_swap_b32 v192, v194
    v_permlane16_swap_b32 v193, v195
    ds_write_b128 v21, v[192:195] offset:12288
    v_pk_mul_f32 v[72:73], v[72:73], v[252:253] op_sel:[0,1] op_sel_hi:[1,1]
    v_pk_mul_f32 v[74:75], v[74:75], v[252:253] op_sel:[0,1] op_sel_hi:[1,1]
    s_waitcnt vmcnt(10)
    ds_read_b128 a[160:163], v17 offset:4096
    ds_read_b128 a[164:167], v18 offset:4096
    v_pk_mul_f32 v[76:77], v[76:77], v[252:253] op_sel:[0,1] op_sel_hi:[1,1]
    s_waitcnt lgkmcnt(3)
    s_add_u32 m0, s83, 2048
    s_xor_b32 s77, s87, 768
    s_xor_b32 s77, s77, s61
    buffer_load_dwordx4 v10, s[12:15], s77 offen lds
    v_pk_mul_f32 v[78:79], v[78:79], v[252:253] op_sel:[0,1] op_sel_hi:[1,1]
    v_pk_fma_f32 v[72:73], v[96:97], v[254:255], v[72:73] op_sel_hi:[1,0,1]
    v_pk_fma_f32 v[74:75], v[98:99], v[254:255], v[74:75] op_sel_hi:[1,0,1]
    v_pk_fma_f32 v[76:77], v[100:101], v[254:255], v[76:77] op_sel_hi:[1,0,1]
    v_pk_fma_f32 v[78:79], v[102:103], v[254:255], v[78:79] op_sel_hi:[1,0,1]
    v_cvt_pk_bf16_f32 v196, v72, v73
    buffer_load_dwordx4 v11, s[12:15], s77 offen offset:1024 lds
    v_cvt_pk_bf16_f32 v197, v74, v75
    v_cvt_pk_bf16_f32 v198, v76, v77
    v_cvt_pk_bf16_f32 v199, v78, v79
    s_nop 0
    v_permlane16_swap_b32 v196, v198
    v_permlane16_swap_b32 v197, v199
    ds_write_b128 v21, v[196:199] offset:14336
    v_pk_mul_f32 v[80:81], v[80:81], v[252:253] op_sel:[0,1] op_sel_hi:[1,1]
    v_pk_mul_f32 v[82:83], v[82:83], v[252:253] op_sel:[0,1] op_sel_hi:[1,1]
    v_pk_mul_f32 v[84:85], v[84:85], v[252:253] op_sel:[0,1] op_sel_hi:[1,1]
    v_pk_mul_f32 v[86:87], v[86:87], v[252:253] op_sel:[0,1] op_sel_hi:[1,1]
    v_pk_fma_f32 v[80:81], v[104:105], v[254:255], v[80:81] op_sel_hi:[1,0,1]
    v_pk_fma_f32 v[82:83], v[106:107], v[254:255], v[82:83] op_sel_hi:[1,0,1]
    s_waitcnt vmcnt(10)
    ds_read_b128 a[168:171], v17 offset:6144
    ds_read_b128 a[172:175], v18 offset:6144
    v_pk_fma_f32 v[84:85], v[108:109], v[254:255], v[84:85] op_sel_hi:[1,0,1]
    s_waitcnt lgkmcnt(3)
    s_add_u32 m0, s83, 4096
    s_xor_b32 s77, s88, 768
    s_xor_b32 s77, s77, s61
    buffer_load_dwordx4 v10, s[12:15], s77 offen lds
    v_pk_fma_f32 v[86:87], v[110:111], v[254:255], v[86:87] op_sel_hi:[1,0,1]
    v_cvt_pk_bf16_f32 v200, v80, v81
    v_cvt_pk_bf16_f32 v201, v82, v83
    v_cvt_pk_bf16_f32 v202, v84, v85
    v_cvt_pk_bf16_f32 v203, v86, v87
    s_nop 0
    v_permlane16_swap_b32 v200, v202
    v_permlane16_swap_b32 v201, v203
    buffer_load_dwordx4 v11, s[12:15], s77 offen offset:1024 lds
    ds_write_b128 v21, v[200:203] offset:16384
    s_waitcnt vmcnt(5)
L_chk_3:
    v_cmp_ne_u32 vcc, s68, v48
    s_nop 0
    s_cbranch_vccz L_ok_4
    s_cmp_eq_u32 s69, 0
    s_cbranch_scc1 L_ok_4
    s_sub_u32 s69, s69, 1
    buffer_load_dword v48, v22, s[20:23], s95 offen sc1
    s_waitcnt vmcnt(0)
    s_branch L_chk_3
L_ok_4:
    s_waitcnt lgkmcnt(0)
    ds_read_b128 a[176:179], v17 offset:8192
    ds_read_b128 a[180:183], v18 offset:8192
    s_barrier
    s_add_u32 m0, s83, 6144
    s_xor_b32 s77, s89, 768
    s_xor_b32 s77, s77, s61
    buffer_load_dwordx4 v10, s[12:15], s77 offen lds
    buffer_load_dwordx4 v11, s[12:15], s77 offen offset:1024 lds
    ds_read_b128 v[128:131], v13 offset:12288
    ds_read_b128 v[132:135], v13 offset:18432
    ds_read_b128 v[136:139], v14 offset:12288
    ds_read_b128 v[140:143], v14 offset:18432
    s_waitcnt lgkmcnt(3)
    v_mfma_f32_16x16x32_bf16 v[64:67], v[128:131], v[240:243], 0
    ds_read_b128 v[160:163], v13 offset:14336
    v_mfma_f32_16x16x32_bf16 v[68:71], v[128:131], v[152:155], 0
    ds_read_b128 v[164:167], v13 offset:20480
    s_waitcnt lgkmcnt(3)
    v_mfma_f32_16x16x32_bf16 v[64:67], v[136:139], v[144:147], v[64:67]
    ds_read_b128 v[168:171], v14 offset:14336
    v_mfma_f32_16x16x32_bf16 v[68:71], v[136:139], v[156:159], v[68:71]
    ds_read_b128 v[172:175], v14 offset:20480
    v_mfma_f32_16x16x32_bf16 v[64:67], v[132:135], v[244:247], v[64:67]
    ds_read_b128 a[184:187], v17 offset:10240
    ds_read_b128 a[188:191], v18 offset:10240
    v_mfma_f32_16x16x32_bf16 v[68:71], v[132:135], v[240:243], v[68:71]
    s_add_u32 m0, s83, 8192
    s_xor_b32 s77, s86, 896
    s_xor_b32 s77, s77, s61
    buffer_load_dwordx4 v10, s[12:15], s77 offen lds
    s_waitcnt lgkmcnt(6)
    v_mfma_f32_16x16x32_bf16 v[64:67], v[140:143], v[148:151], v[64:67]
    buffer_load_dwordx4 v11, s[12:15], s77 offen offset:1024 lds
    v_mfma_f32_16x16x32_bf16 v[68:71], v[140:143], v[144:147], v[68:71]
    s_waitcnt lgkmcnt(5)
    v_mfma_f32_16x16x32_bf16 v[72:75], v[160:163], v[240:243], 0
    ds_read_b128 v[128:131], v34 offset:12288
    v_mfma_f32_16x16x32_bf16 v[76:79], v[160:163], v[152:155], 0
    ds_read_b128 v[132:135], v34 offset:18432
    s_waitcnt lgkmcnt(5)
    v_mfma_f32_16x16x32_bf16 v[72:75], v[168:171], v[144:147], v[72:75]
    ds_read_b128 v[136:139], v35 offset:12288
    v_mfma_f32_16x16x32_bf16 v[76:79], v[168:171], v[156:159], v[76:79]
    ds_read_b128 v[140:143], v35 offset:18432
    v_cvt_pk_bf16_f32 v192, v64, v65
    v_mfma_f32_16x16x32_bf16 v[72:75], v[164:167], v[244:247], v[72:75]
    v_cvt_pk_bf16_f32 v193, v66, v67
    v_cvt_pk_bf16_f32 v194, v68, v69
    v_mfma_f32_16x16x32_bf16 v[76:79], v[164:167], v[240:243], v[76:79]
    v_cvt_pk_bf16_f32 v195, v70, v71
    s_waitcnt lgkmcnt(6)
    v_mfma_f32_16x16x32_bf16 v[72:75], v[172:175], v[148:151], v[72:75]
    ds_write_b128 v19, v[192:195] offset:0
    v_mfma_f32_16x16x32_bf16 v[76:79], v[172:175], v[144:147], v[76:79]
    s_waitcnt vmcnt(8)
    ds_read_b128 a[192:195], v17 offset:0
    ds_read_b128 a[196:199], v18 offset:0
    s_waitcnt lgkmcnt(6)
    v_mfma_f32_16x16x32_bf16 v[80:83], v[128:131], v[240:243], 0
    s_waitcnt lgkmcnt(5)
    v_xor_b32 v132, v39, v132
    v_xor_b32 v133, v39, v133
    s_add_u32 m0, s83, 10240
    s_xor_b32 s77, s87, 896
    s_xor_b32 s77, s77, s61
    buffer_load_dwordx4 v10, s[12:15], s77 offen lds
    v_mfma_f32_16x16x32_bf16 v[84:87], v[128:131], v[152:155], 0
    v_xor_b32 v134, v39, v134
    v_xor_b32 v135, v39, v135
    s_waitcnt lgkmcnt(4)
    v_mfma_f32_16x16x32_bf16 v[80:83], v[136:139], v[144:147], v[80:83]
    s_waitcnt lgkmcnt(3)
    v_xor_b32 v140, v39, v140
    v_xor_b32 v141, v39, v141
    v_mfma_f32_16x16x32_bf16 v[84:87], v[136:139], v[156:159], v[84:87]
    v_xor_b32 v142, v39, v142
    v_xor_b32 v143, v39, v143
    v_mfma_f32_16x16x32_bf16 v[80:83], v[132:135], v[244:247], v[80:83]
    ds_read_b128 v[160:163], v36 offset:14336
    v_cvt_pk_bf16_f32 v196, v72, v73
    v_cvt_pk_bf16_f32 v197, v74, v75
    v_mfma_f32_16x16x32_bf16 v[84:87], v[132:135], v[240:243], v[84:87]
    ds_read_b128 v[164:167], v36 offset:20480
    v_cvt_pk_bf16_f32 v198, v76, v77
    buffer_load_dwordx4 v11, s[12:15], s77 offen offset:1024 lds
    v_mfma_f32_16x16x32_bf16 v[80:83], v[140:143], v[148:151], v[80:83]
    ds_read_b128 v[168:171], v37 offset:14336
    v_cvt_pk_bf16_f32 v199, v78, v79
    v_mfma_f32_16x16x32_bf16 v[84:87], v[140:143], v[144:147], v[84:87]
    ds_read_b128 v[172:175], v37 offset:20480
    ds_write_b128 v19, v[196:199] offset:64
    s_waitcnt lgkmcnt(4)
    v_mfma_f32_16x16x32_bf16 v[88:91], v[160:163], v[240:243], 0
    ds_read_b128 v[128:131], v36 offset:12288
    v_mfma_f32_16x16x32_bf16 v[92:95], v[160:163], v[152:155], 0
    ds_read_b128 v[132:135], v36 offset:18432
    s_waitcnt lgkmcnt(4)
    v_mfma_f32_16x16x32_bf16 v[88:91], v[168:171], v[144:147], v[88:91]
    ds_read_b128 v[136:139], v37 offset:12288
    v_mfma_f32_16x16x32_bf16 v[92:95], v[168:171], v[156:159], v[92:95]
    ds_read_b128 v[140:143], v37 offset:18432
    v_cvt_pk_bf16_f32 v200, v80, v81
    s_waitcnt vmcnt(8)
    ds_read_b128 a[200:203], v17 offset:2048
    ds_read_b128 a[204:207], v18 offset:2048
    v_mfma_f32_16x16x32_bf16 v[88:91], v[164:167], v[152:155], v[88:91]
    s_add_u32 m0, s83, 0
    s_xor_b32 s77, s88, 896
    s_xor_b32 s77, s77, s61
    buffer_load_dwordx4 v10, s[12:15], s77 offen lds
    v_cvt_pk_bf16_f32 v201, v82, v83
    v_cvt_pk_bf16_f32 v202, v84, v85
    v_mfma_f32_16x16x32_bf16 v[92:95], v[164:167], v[176:179], v[92:95]
    buffer_load_dwordx4 v11, s[12:15], s77 offen offset:1024 lds
    v_cvt_pk_bf16_f32 v203, v86, v87
    s_waitcnt lgkmcnt(7)
    v_mfma_f32_16x16x32_bf16 v[88:91], v[172:175], v[156:159], v[88:91]
    ds_write_b128 v38, v[200:203] offset:128
    v_mfma_f32_16x16x32_bf16 v[92:95], v[172:175], v[180:183], v[92:95]
    s_waitcnt vmcnt(8)
    ds_read_b128 a[208:211], v17 offset:4096
    ds_read_b128 a[212:215], v18 offset:4096
    s_waitcnt lgkmcnt(8)
    v_mfma_f32_16x16x32_bf16 v[96:99], v[128:131], v[240:243], 0
    s_waitcnt lgkmcnt(3)
    s_add_u32 m0, s83, 2048
    s_xor_b32 s77, s89, 896
    s_xor_b32 s77, s77, s61
    buffer_load_dwordx4 v10, s[12:15], s77 offen lds
    v_mfma_f32_16x16x32_bf16 v[100:103], v[128:131], v[152:155], 0
    v_mfma_f32_16x16x32_bf16 v[96:99], v[136:139], v[144:147], v[96:99]
    buffer_load_dwordx4 v11, s[12:15], s77 offen offset:1024 lds
    v_mfma_f32_16x16x32_bf16 v[100:103], v[136:139], v[156:159], v[100:103]
    v_cvt_pk_bf16_f32 v204, v88, v89
    v_cvt_pk_bf16_f32 v205, v90, v91
    v_mfma_f32_16x16x32_bf16 v[96:99], v[132:135], v[152:155], v[96:99]
    v_cvt_pk_bf16_f32 v206, v92, v93
    v_cvt_pk_bf16_f32 v207, v94, v95
    v_mfma_f32_16x16x32_bf16 v[100:103], v[132:135], v[176:179], v[100:103]
    ds_write_b128 v19, v[204:207] offset:352
    v_mfma_f32_16x16x32_bf16 v[96:99], v[140:143], v[156:159], v[96:99]
    s_waitcnt vmcnt(8)
    ds_read_b128 a[216:219], v17 offset:6144
    ds_read_b128 a[220:223], v18 offset:6144
    v_mfma_f32_16x16x32_bf16 v[100:103], v[140:143], v[180:183], v[100:103]
    s_add_u32 m0, s101, 0
    s_xor_b32 s77, s90, 0
    buffer_load_dwordx4 v12, s[20:23], s77 offen offset:0 sc1 lds
    s_nop 0
    v_cvt_pk_bf16_f32 v208, v96, v97
    v_cvt_pk_bf16_f32 v209, v98, v99
    s_nop 1
    v_cvt_pk_bf16_f32 v210, v100, v101
    v_cvt_pk_bf16_f32 v211, v102, v103
    ds_write_b128 v19, v[208:211] offset:416
    s_waitcnt lgkmcnt(0)
    buffer_load_dwordx4 v12, s[20:23], s77 offen offset:1024 sc1 lds
    ds_read_b128 v[192:195], v112 offset:0
    s_waitcnt vmcnt(8)
    ds_read_b128 a[224:227], v17 offset:8192
    ds_read_b128 a[228:231], v18 offset:8192
    ds_read_b128 v[196:199], v113 offset:1024
    buffer_load_dwordx4 v12, s[20:23], s77 offen offset:2048 sc1 lds
    ds_read_b128 v[200:203], v114 offset:2048
    ds_read_b128 v[204:207], v115 offset:3072
    ds_read_b128 v[208:211], v120 offset:4096
    v_bfe_u32 v42, v1, 2, 2
    buffer_load_dwordx4 v12, s[20:23], s77 offen offset:3072 sc1 lds
    v_lshl_add_u32 v40, v251, 3, v42
    v_lshlrev_b32 v40, 8, v40
    v_and_b32 v41, 1, v251
    v_lshl_add_u32 v40, v41, 7, v40
    v_bfe_u32 v41, v1, 1, 1
    v_lshl_add_u32 v40, v41, 6, v40
    v_lshl_add_u32 v40, v42, 4, v40
    v_and_b32 v41, 1, v1
    v_lshl_add_u32 v40, v41, 3, v40
    s_bfe_u32 s78, s3, 0x20001
    s_lshl_b32 s78, s78, 4
    s_lshl_b32 s79, s67, 7
    s_or_b32 s78, s78, s79
    s_waitcnt vmcnt(8)
    ds_read_b128 a[232:235], v17 offset:10240
    ds_read_b128 a[236:239], v18 offset:10240
    v_xor_b32 v40, s78, v40
    s_add_u32 m0, s101, 4096
    s_add_u32 s77, s77, 4096
    buffer_load_dwordx4 v12, s[20:23], s77 offen offset:0 sc1 lds
    v_add_u32 v32, s101, v40
    v_xor_b32 v33, 16, v32
    v_xor_b32 v34, 32, v32
    v_xor_b32 v35, 48, v32
    v_xor_b32 v36, 128, v32
    v_xor_b32 v37, 144, v32
    v_xor_b32 v38, 160, v32
    v_xor_b32 v39, 176, v32
    buffer_load_dwordx4 v12, s[20:23], s77 offen offset:1024 sc1 lds
    s_lshl_b32 s78, s64, 3
    s_add_u32 s78, s78, s66
    s_lshl_b32 s78, s78, 5
    s_add_u32 s78, s78, s65
    s_lshl_b32 s78, s78, 5
    s_add_u32 s2, s78, 65536
    s_waitcnt vmcnt(8)
    ds_read_b128 a[240:243], v17 offset:0
    ds_read_b128 a[244:247], v18 offset:0
    buffer_load_dwordx4 v12, s[20:23], s77 offen offset:2048 sc1 lds
    buffer_load_dwordx4 v12, s[20:23], s77 offen offset:3072 sc1 lds
    s_waitcnt vmcnt(8)
    ds_read_b128 a[248:251], v17 offset:2048
    ds_read_b128 a[252:255], v18 offset:2048
    s_waitcnt lgkmcnt(0)
    s_barrier
    s_add_u32 m0, s101, 8192
    s_xor_b32 s77, s90, 32768
    buffer_load_dwordx4 v12, s[20:23], s77 offen offset:0 sc1 lds
    v_mov_b32 v240, v28
    buffer_load_dwordx4 v12, s[20:23], s77 offen offset:1024 sc1 lds
    v_mov_b32 v241, v28
    v_mov_b32 v242, v28
    v_mov_b32 v243, v28
    v_mov_b32 v244, v23
    v_mov_b32 v245, v23
    v_mov_b32 v246, v23
    buffer_load_dwordx4 v12, s[20:23], s77 offen offset:2048 sc1 lds
    v_mov_b32 v247, v23
    v_lshlrev_b32 v10, 7, v252
    v_lshlrev_b32 v11, 5, v1
    buffer_load_dwordx4 v12, s[20:23], s77 offen offset:3072 sc1 lds
    s_add_u32 m0, s101, 12288
    s_add_u32 s77, s77, 4096
    buffer_load_dwordx4 v12, s[20:23], s77 offen offset:0 sc1 lds
    buffer_load_dwordx4 v12, s[20:23], s77 offen offset:1024 sc1 lds
    buffer_load_dwordx4 v12, s[20:23], s77 offen offset:2048 sc1 lds
    buffer_load_dwordx4 v12, s[20:23], s77 offen offset:3072 sc1 lds
    s_waitcnt vmcnt(8)
    s_add_u32 m0, s101, 16384
    s_xor_b32 s77, s90, 8192
    buffer_load_dwordx4 v12, s[20:23], s77 offen offset:0 sc1 lds
    ds_read_b64_tr_b16 v[128:129], v32 offset:0
    ds_read_b64_tr_b16 v[130:131], v32 offset:1024
    buffer_load_dwordx4 v12, s[20:23], s77 offen offset:1024 sc1 lds
    ds_read_b64_tr_b16 v[132:133], v36 offset:0
    ds_read_b64_tr_b16 v[134:135], v36 offset:1024
    ds_read_b64_tr_b16 v[136:137], v33 offset:0
    ds_read_b64_tr_b16 v[138:139], v33 offset:1024
    ds_read_b64_tr_b16 v[140:141], v37 offset:0
    ds_read_b64_tr_b16 v[142:143], v37 offset:1024
    ds_read_b64_tr_b16 v[144:145], v34 offset:0
    ds_read_b64_tr_b16 v[146:147], v34 offset:1024
    ds_read_b64_tr_b16 v[148:149], v38 offset:0
    ds_read_b64_tr_b16 v[150:151], v38 offset:1024
    ds_read_b64_tr_b16 v[152:153], v35 offset:0
    buffer_load_dwordx4 v12, s[20:23], s77 offen offset:2048 sc1 lds
    ds_read_b64_tr_b16 v[154:155], v35 offset:1024
    ds_read_b64_tr_b16 v[156:157], v39 offset:0
    ds_read_b64_tr_b16 v[158:159], v39 offset:1024
    s_waitcnt lgkmcnt(0)
    buffer_load_dwordx4 v12, s[20:23], s77 offen offset:3072 sc1 lds
    s_add_u32 m0, s101, 20480
    s_add_u32 s77, s77, 4096
    buffer_load_dwordx4 v12, s[20:23], s77 offen offset:0 sc1 lds
    v_mfma_f32_16x16x32_bf16 v[64:67], v[128:131], a[0:3], v[240:243]
    v_mul_f32 v52, v216, v216
    v_mul_f32 v53, v217, v217
    v_mfma_f32_16x16x32_bf16 v[80:83], v[132:135], a[0:3], 0
    v_mul_f32 v54, v218, v218
    v_mfma_f32_16x16x32_bf16 v[68:71], v[128:131], a[8:11], v[244:247]
    v_mul_f32 v55, v219, v219
    v_fma_f32 v52, v52, s92, v248
    v_mfma_f32_16x16x32_bf16 v[84:87], v[132:135], a[8:11], 0
    v_fma_f32 v53, v53, s92, v248
    v_fma_f32 v54, v54, s92, v248
    v_mfma_f32_16x16x32_bf16 v[72:75], v[128:131], a[16:19], 0
    v_fma_f32 v55, v55, s92, v248
    v_mul_f32 v52, v52, v216
    v_mfma_f32_16x16x32_bf16 v[88:91], v[132:135], a[16:19], 0
    buffer_load_dwordx4 v12, s[20:23], s77 offen offset:1024 sc1 lds
    v_mul_f32 v53, v53, v217
    v_mfma_f32_16x16x32_bf16 v[76:79], v[128:131], a[24:27], 0
    v_mul_f32 v54, v54, v218
    v_mul_f32 v55, v55, v219
    v_mfma_f32_16x16x32_bf16 v[92:95], v[132:135], a[24:27], 0
    v_exp_f32 v52, v52
    v_exp_f32 v53, v53
    v_mfma_f32_16x16x32_bf16 v[64:67], v[136:139], a[32:35], v[64:67]
    buffer_load_dwordx4 v12, s[20:23], s77 offen offset:2048 sc1 lds
    buffer_load_dwordx4 v12, s[20:23], s77 offen offset:3072 sc1 lds
    s_add_u32 m0, s101, 0
    s_xor_b32 s77, s90, 40960
    buffer_load_dwordx4 v12, s[20:23], s77 offen offset:0 sc1 lds
    buffer_load_dwordx4 v12, s[20:23], s77 offen offset:1024 sc1 lds
    s_waitcnt vmcnt(10)
    ds_read_b64_tr_b16 v[160:161], v32 offset:8192
    v_exp_f32 v54, v54
    v_mfma_f32_16x16x32_bf16 v[80:83], v[140:143], a[32:35], v[80:83]
    buffer_load_dwordx4 v12, s[20:23], s77 offen offset:2048 sc1 lds
    ds_read_b64_tr_b16 v[162:163], v32 offset:9216
    v_mfma_f32_16x16x32_bf16 v[68:71], v[136:139], a[40:43], v[68:71]
    ds_read_b64_tr_b16 v[164:165], v36 offset:8192
    v_exp_f32 v55, v55
    v_mfma_f32_16x16x32_bf16 v[84:87], v[140:143], a[40:43], v[84:87]
    ds_read_b64_tr_b16 v[166:167], v36 offset:9216
    v_add_f32 v52, 1.0, v52
    v_mfma_f32_16x16x32_bf16 v[72:75], v[136:139], a[48:51], v[72:75]
    ds_read_b64_tr_b16 v[168:169], v33 offset:8192
    v_add_f32 v53, 1.0, v53
    v_mfma_f32_16x16x32_bf16 v[88:91], v[140:143], a[48:51], v[88:91]
    buffer_load_dwordx4 v12, s[20:23], s77 offen offset:3072 sc1 lds
    ds_read_b64_tr_b16 v[170:171], v33 offset:9216
    v_mfma_f32_16x16x32_bf16 v[76:79], v[136:139], a[56:59], v[76:79]
    ds_read_b64_tr_b16 v[172:173], v37 offset:8192
    v_add_f32 v54, 1.0, v54
    v_mfma_f32_16x16x32_bf16 v[92:95], v[140:143], a[56:59], v[92:95]
    ds_read_b64_tr_b16 v[174:175], v37 offset:9216
    v_add_f32 v55, 1.0, v55
    v_mfma_f32_16x16x32_bf16 v[64:67], v[144:147], a[64:67], v[64:67]
    ds_read_b64_tr_b16 v[176:177], v34 offset:8192
    v_rcp_f32 v52, v52
    v_mfma_f32_16x16x32_bf16 v[80:83], v[148:151], a[64:67], v[80:83]
    s_add_u32 m0, s101, 4096
    s_add_u32 s77, s77, 4096
    buffer_load_dwordx4 v12, s[20:23], s77 offen offset:0 sc1 lds
    ds_read_b64_tr_b16 v[178:179], v34 offset:9216
    v_mfma_f32_16x16x32_bf16 v[68:71], v[144:147], a[72:75], v[68:71]
    ds_read_b64_tr_b16 v[180:181], v38 offset:8192
    v_rcp_f32 v53, v53
    v_mfma_f32_16x16x32_bf16 v[84:87], v[148:151], a[72:75], v[84:87]
    ds_read_b64_tr_b16 v[182:183], v38 offset:9216
    v_rcp_f32 v54, v54
    v_mfma_f32_16x16x32_bf16 v[72:75], v[144:147], a[80:83], v[72:75]
    ds_read_b64_tr_b16 v[184:185], v35 offset:8192
    v_rcp_f32 v55, v55
    v_mfma_f32_16x16x32_bf16 v[88:91], v[148:151], a[80:83], v[88:91]
    buffer_load_dwordx4 v12, s[20:23], s77 offen offset:1024 sc1 lds
    ds_read_b64_tr_b16 v[186:187], v35 offset:9216
    v_mfma_f32_16x16x32_bf16 v[76:79], v[144:147], a[88:91], v[76:79]
    ds_read_b64_tr_b16 v[188:189], v39 offset:8192
    v_mul_f32 v216, v216, v52
    v_mfma_f32_16x16x32_bf16 v[92:95], v[148:151], a[88:91], v[92:95]
    ds_read_b64_tr_b16 v[190:191], v39 offset:9216
    v_mul_f32 v217, v217, v53
    v_mfma_f32_16x16x32_bf16 v[64:67], v[152:155], a[96:99], v[64:67]
    v_mul_f32 v218, v218, v54
    v_mul_f32 v219, v219, v55
    v_mfma_f32_16x16x32_bf16 v[80:83], v[156:159], a[96:99], v[80:83]
    buffer_load_dwordx4 v12, s[20:23], s77 offen offset:2048 sc1 lds
    v_mfma_f32_16x16x32_bf16 v[68:71], v[152:155], a[104:107], v[68:71]
    buffer_load_dwordx4 v12, s[20:23], s77 offen offset:3072 sc1 lds
    v_mfma_f32_16x16x32_bf16 v[84:87], v[156:159], a[104:107], v[84:87]
    v_mfma_f32_16x16x32_bf16 v[72:75], v[152:155], a[112:115], v[72:75]
    v_mfma_f32_16x16x32_bf16 v[88:91], v[156:159], a[112:115], v[88:91]
    v_mfma_f32_16x16x32_bf16 v[76:79], v[152:155], a[120:123], v[76:79]
    v_mfma_f32_16x16x32_bf16 v[92:95], v[156:159], a[120:123], v[92:95]
    s_waitcnt lgkmcnt(0)
    v_mfma_f32_16x16x32_bf16 v[64:67], v[160:163], a[4:7], v[64:67]
    v_mul_f32 v52, v220, v220
    v_mul_f32 v53, v221, v221
    v_mfma_f32_16x16x32_bf16 v[80:83], v[164:167], a[4:7], v[80:83]
    s_add_u32 m0, s101, 8192
    s_xor_b32 s77, s90, 0
    s_add_u32 s77, s77, 131072
    buffer_load_dwordx4 v12, s[20:23], s77 offen offset:0 sc1 lds
    v_mul_f32 v54, v222, v222
    v_mfma_f32_16x16x32_bf16 v[68:71], v[160:163], a[12:15], v[68:71]
    v_mul_f32 v55, v223, v223
    v_fma_f32 v52, v52, s92, v248
    v_mfma_f32_16x16x32_bf16 v[84:87], v[164:167], a[12:15], v[84:87]
    v_fma_f32 v53, v53, s92, v248
    v_fma_f32 v54, v54, s92, v248
    v_mfma_f32_16x16x32_bf16 v[72:75], v[160:163], a[20:23], v[72:75]
    v_fma_f32 v55, v55, s92, v248
    v_mul_f32 v52, v52, v220
    v_mfma_f32_16x16x32_bf16 v[88:91], v[164:167], a[20:23], v[88:91]
    buffer_load_dwordx4 v12, s[20:23], s77 offen offset:1024 sc1 lds
    v_mul_f32 v53, v53, v221
    v_mfma_f32_16x16x32_bf16 v[76:79], v[160:163], a[28:31], v[76:79]
    v_mul_f32 v54, v54, v222
    v_mul_f32 v55, v55, v223
    v_mfma_f32_16x16x32_bf16 v[92:95], v[164:167], a[28:31], v[92:95]
    v_exp_f32 v52, v52
    v_exp_f32 v53, v53
    v_mfma_f32_16x16x32_bf16 v[64:67], v[168:171], a[36:39], v[64:67]
    v_xor_b32 v32, s59, v32
    v_exp_f32 v54, v54
    v_mfma_f32_16x16x32_bf16 v[80:83], v[172:175], a[36:39], v[80:83]
    buffer_load_dwordx4 v12, s[20:23], s77 offen offset:2048 sc1 lds
    v_xor_b32 v33, s59, v33
    v_mfma_f32_16x16x32_bf16 v[68:71], v[168:171], a[44:47], v[68:71]
    v_xor_b32 v34, s59, v34
    v_exp_f32 v55, v55
    v_mfma_f32_16x16x32_bf16 v[84:87], v[172:175], a[44:47], v[84:87]
    v_xor_b32 v35, s59, v35
    v_add_f32 v52, 1.0, v52
    v_mfma_f32_16x16x32_bf16 v[72:75], v[168:171], a[52:55], v[72:75]
    v_xor_b32 v36, s59, v36
    v_add_f32 v53, 1.0, v53
    v_mfma_f32_16x16x32_bf16 v[88:91], v[172:175], a[52:55], v[88:91]
    buffer_load_dwordx4 v12, s[20:23], s77 offen offset:3072 sc1 lds
    v_xor_b32 v37, s59, v37
    v_mfma_f32_16x16x32_bf16 v[76:79], v[168:171], a[60:63], v[76:79]
    v_xor_b32 v38, s59, v38
    v_add_f32 v54, 1.0, v54
    v_mfma_f32_16x16x32_bf16 v[92:95], v[172:175], a[60:63], v[92:95]
    v_xor_b32 v39, s59, v39
    s_waitcnt vmcnt(12)
    v_add_f32 v55, 1.0, v55
    v_mfma_f32_16x16x32_bf16 v[64:67], v[176:179], a[68:71], v[64:67]
    ds_read_b64_tr_b16 v[128:129], v32 offset:16384
    v_rcp_f32 v52, v52
    v_mfma_f32_16x16x32_bf16 v[80:83], v[180:183], a[68:71], v[80:83]
    s_add_u32 m0, s101, 12288
    s_add_u32 s77, s77, 4096
    buffer_load_dwordx4 v12, s[20:23], s77 offen offset:0 sc1 lds
    ds_read_b64_tr_b16 v[130:131], v32 offset:17408
    v_mfma_f32_16x16x32_bf16 v[68:71], v[176:179], a[76:79], v[68:71]
    ds_read_b64_tr_b16 v[132:133], v36 offset:16384
    v_rcp_f32 v53, v53
    v_mfma_f32_16x16x32_bf16 v[84:87], v[180:183], a[76:79], v[84:87]
    ds_read_b64_tr_b16 v[134:135], v36 offset:17408
    v_rcp_f32 v54, v54
    v_mfma_f32_16x16x32_bf16 v[72:75], v[176:179], a[84:87], v[72:75]
    ds_read_b64_tr_b16 v[136:137], v33 offset:16384
    v_rcp_f32 v55, v55
    v_mfma_f32_16x16x32_bf16 v[88:91], v[180:183], a[84:87], v[88:91]
    buffer_load_dwordx4 v12, s[20:23], s77 offen offset:1024 sc1 lds
    ds_read_b64_tr_b16 v[138:139], v33 offset:17408
    v_mfma_f32_16x16x32_bf16 v[76:79], v[176:179], a[92:95], v[76:79]
    ds_read_b64_tr_b16 v[140:141], v37 offset:16384
    v_mul_f32 v220, v220, v52
    v_mfma_f32_16x16x32_bf16 v[92:95], v[180:183], a[92:95], v[92:95]
    ds_read_b64_tr_b16 v[142:143], v37 offset:17408
    v_mul_f32 v221, v221, v53
    v_mfma_f32_16x16x32_bf16 v[64:67], v[184:187], a[100:103], v[64:67]
    ds_read_b64_tr_b16 v[144:145], v34 offset:16384
    v_mul_f32 v222, v222, v54
    v_mfma_f32_16x16x32_bf16 v[80:83], v[188:191], a[100:103], v[80:83]
    buffer_load_dwordx4 v12, s[20:23], s77 offen offset:2048 sc1 lds
    ds_read_b64_tr_b16 v[146:147], v34 offset:17408
    v_mfma_f32_16x16x32_bf16 v[68:71], v[184:187], a[108:111], v[68:71]
    ds_read_b64_tr_b16 v[148:149], v38 offset:16384
    v_mul_f32 v223, v223, v55
    v_mfma_f32_16x16x32_bf16 v[84:87], v[188:191], a[108:111], v[84:87]
    buffer_load_dwordx4 v12, s[20:23], s77 offen offset:3072 sc1 lds
    ds_read_b64_tr_b16 v[150:151], v38 offset:17408
    v_mfma_f32_16x16x32_bf16 v[72:75], v[184:187], a[116:119], v[72:75]
    ds_read_b64_tr_b16 v[152:153], v35 offset:16384
    v_mfma_f32_16x16x32_bf16 v[88:91], v[188:191], a[116:119], v[88:91]
    ds_read_b64_tr_b16 v[154:155], v35 offset:17408
    v_mfma_f32_16x16x32_bf16 v[76:79], v[184:187], a[124:127], v[76:79]
    ds_read_b64_tr_b16 v[156:157], v39 offset:16384
    v_mfma_f32_16x16x32_bf16 v[92:95], v[188:191], a[124:127], v[92:95]
    ds_read_b64_tr_b16 v[158:159], v39 offset:17408
    s_waitcnt lgkmcnt(0)
    s_add_u32 m0, s101, 16384
    s_xor_b32 s77, s90, 32768
    s_add_u32 s77, s77, 131072
    buffer_load_dwordx4 v12, s[20:23], s77 offen offset:0 sc1 lds
    v_mfma_f32_16x16x32_bf16 v[64:67], v[128:131], a[128:131], v[64:67]
    v_mul_f32 v52, v224, v224
    v_mul_f32 v53, v225, v225
    v_mfma_f32_16x16x32_bf16 v[80:83], v[132:135], a[128:131], v[80:83]
    buffer_load_dwordx4 v12, s[20:23], s77 offen offset:1024 sc1 lds
    v_mul_f32 v54, v226, v226
    v_mfma_f32_16x16x32_bf16 v[68:71], v[128:131], a[136:139], v[68:71]
    v_mul_f32 v55, v227, v227
    v_fma_f32 v52, v52, s92, v248
    v_mfma_f32_16x16x32_bf16 v[84:87], v[132:135], a[136:139], v[84:87]
    v_fma_f32 v53, v53, s92, v248
    v_fma_f32 v54, v54, s92, v248
    v_mfma_f32_16x16x32_bf16 v[72:75], v[128:131], a[144:147], v[72:75]
    v_fma_f32 v55, v55, s92, v248
    v_mul_f32 v52, v52, v224
    v_mfma_f32_16x16x32_bf16 v[88:91], v[132:135], a[144:147], v[88:91]
    buffer_load_dwordx4 v12, s[20:23], s77 offen offset:2048 sc1 lds
    v_mul_f32 v53, v53, v225
    v_mfma_f32_16x16x32_bf16 v[76:79], v[128:131], a[152:155], v[76:79]
    v_mul_f32 v54, v54, v226
    v_mul_f32 v55, v55, v227
    v_mfma_f32_16x16x32_bf16 v[92:95], v[132:135], a[152:155], v[92:95]
    v_exp_f32 v52, v52
    v_exp_f32 v53, v53
    v_mfma_f32_16x16x32_bf16 v[64:67], v[136:139], a[160:163], v[64:67]
    s_waitcnt vmcnt(11)
    ds_read_b64_tr_b16 v[160:161], v32 offset:0
    v_exp_f32 v54, v54
    v_mfma_f32_16x16x32_bf16 v[80:83], v[140:143], a[160:163], v[80:83]
    buffer_load_dwordx4 v12, s[20:23], s77 offen offset:3072 sc1 lds
    ds_read_b64_tr_b16 v[162:163], v32 offset:1024
    v_mfma_f32_16x16x32_bf16 v[68:71], v[136:139], a[168:171], v[68:71]
    ds_read_b64_tr_b16 v[164:165], v36 offset:0
    v_exp_f32 v55, v55
    v_mfma_f32_16x16x32_bf16 v[84:87], v[140:143], a[168:171], v[84:87]
    ds_read_b64_tr_b16 v[166:167], v36 offset:1024
    v_add_f32 v52, 1.0, v52
    v_mfma_f32_16x16x32_bf16 v[72:75], v[136:139], a[176:179], v[72:75]
    ds_read_b64_tr_b16 v[168:169], v33 offset:0
    v_add_f32 v53, 1.0, v53
    v_mfma_f32_16x16x32_bf16 v[88:91], v[140:143], a[176:179], v[88:91]
    s_add_u32 m0, s101, 20480
    s_add_u32 s77, s77, 4096
    buffer_load_dwordx4 v12, s[20:23], s77 offen offset:0 sc1 lds
    ds_read_b64_tr_b16 v[170:171], v33 offset:1024
    v_mfma_f32_16x16x32_bf16 v[76:79], v[136:139], a[184:187], v[76:79]
    ds_read_b64_tr_b16 v[172:173], v37 offset:0
    v_add_f32 v54, 1.0, v54
    v_mfma_f32_16x16x32_bf16 v[92:95], v[140:143], a[184:187], v[92:95]
    ds_read_b64_tr_b16 v[174:175], v37 offset:1024
    v_add_f32 v55, 1.0, v55
    v_mfma_f32_16x16x32_bf16 v[64:67], v[144:147], a[192:195], v[64:67]
    ds_read_b64_tr_b16 v[176:177], v34 offset:0
    v_rcp_f32 v52, v52
    v_mfma_f32_16x16x32_bf16 v[80:83], v[148:151], a[192:195], v[80:83]
    buffer_load_dwordx4 v12, s[20:23], s77 offen offset:1024 sc1 lds
    ds_read_b64_tr_b16 v[178:179], v34 offset:1024
    v_mfma_f32_16x16x32_bf16 v[68:71], v[144:147], a[200:203], v[68:71]
    ds_read_b64_tr_b16 v[180:181], v38 offset:0
    v_rcp_f32 v53, v53
    v_mfma_f32_16x16x32_bf16 v[84:87], v[148:151], a[200:203], v[84:87]
    ds_read_b64_tr_b16 v[182:183], v38 offset:1024
    v_rcp_f32 v54, v54
    v_mfma_f32_16x16x32_bf16 v[72:75], v[144:147], a[208:211], v[72:75]
    ds_read_b64_tr_b16 v[184:185], v35 offset:0
    v_rcp_f32 v55, v55
    v_mfma_f32_16x16x32_bf16 v[88:91], v[148:151], a[208:211], v[88:91]
    buffer_load_dwordx4 v12, s[20:23], s77 offen offset:2048 sc1 lds
    ds_read_b64_tr_b16 v[186:187], v35 offset:1024
    v_mfma_f32_16x16x32_bf16 v[76:79], v[144:147], a[216:219], v[76:79]
    ds_read_b64_tr_b16 v[188:189], v39 offset:0
    v_mul_f32 v224, v224, v52
    v_mfma_f32_16x16x32_bf16 v[92:95], v[148:151], a[216:219], v[92:95]
    ds_read_b64_tr_b16 v[190:191], v39 offset:1024
    v_mul_f32 v225, v225, v53
    v_mfma_f32_16x16x32_bf16 v[64:67], v[152:155], a[224:227], v[64:67]
    v_mul_f32 v226, v226, v54
    v_mul_f32 v227, v227, v55
    v_mfma_f32_16x16x32_bf16 v[80:83], v[156:159], a[224:227], v[80:83]
    buffer_load_dwordx4 v12, s[20:23], s77 offen offset:3072 sc1 lds
    v_mfma_f32_16x16x32_bf16 v[68:71], v[152:155], a[232:235], v[68:71]
    v_mfma_f32_16x16x32_bf16 v[84:87], v[156:159], a[232:235], v[84:87]
    v_mfma_f32_16x16x32_bf16 v[72:75], v[152:155], a[240:243], v[72:75]
    v_mfma_f32_16x16x32_bf16 v[88:91], v[156:159], a[240:243], v[88:91]
    v_mfma_f32_16x16x32_bf16 v[76:79], v[152:155], a[248:251], v[76:79]
    v_mfma_f32_16x16x32_bf16 v[92:95], v[156:159], a[248:251], v[92:95]
    s_waitcnt lgkmcnt(0)
    v_mfma_f32_16x16x32_bf16 v[64:67], v[160:163], a[132:135], v[64:67]
    s_add_u32 m0, s101, 0
    s_xor_b32 s77, s90, 8192
    s_add_u32 s77, s77, 131072
    buffer_load_dwordx4 v12, s[20:23], s77 offen offset:0 sc1 lds
    buffer_store_dwordx4 v[192:195], v121, s[20:23], s96 offen offset:0 sc1
    v_mul_f32 v52, v228, v228
    v_mul_f32 v53, v229, v229
    v_mfma_f32_16x16x32_bf16 v[80:83], v[164:167], a[132:135], v[80:83]
    buffer_load_dwordx4 v12, s[20:23], s77 offen offset:1024 sc1 lds
    v_mul_f32 v54, v230, v230
    v_mfma_f32_16x16x32_bf16 v[68:71], v[160:163], a[140:143], v[68:71]
    v_mul_f32 v55, v231, v231
    v_fma_f32 v52, v52, s92, v248
    v_mfma_f32_16x16x32_bf16 v[84:87], v[164:167], a[140:143], v[84:87]
    v_fma_f32 v53, v53, s92, v248
    v_fma_f32 v54, v54, s92, v248
    v_mfma_f32_16x16x32_bf16 v[72:75], v[160:163], a[148:151], v[72:75]
    v_fma_f32 v55, v55, s92, v248
    v_mul_f32 v52, v52, v228
    v_mfma_f32_16x16x32_bf16 v[88:91], v[164:167], a[148:151], v[88:91]
    buffer_load_dwordx4 v12, s[20:23], s77 offen offset:2048 sc1 lds
    v_mul_f32 v53, v53, v229
    v_mfma_f32_16x16x32_bf16 v[76:79], v[160:163], a[156:159], v[76:79]
    buffer_store_dwordx4 v[196:199], v122, s[20:23], s96 offen offset:1024 sc1
    v_mul_f32 v54, v54, v230
    v_mul_f32 v55, v55, v231
    v_mfma_f32_16x16x32_bf16 v[92:95], v[164:167], a[156:159], v[92:95]
    v_exp_f32 v52, v52
    v_exp_f32 v53, v53
    v_mfma_f32_16x16x32_bf16 v[64:67], v[168:171], a[164:167], v[64:67]
    v_xor_b32 v32, s59, v32
    v_exp_f32 v54, v54
    v_mfma_f32_16x16x32_bf16 v[80:83], v[172:175], a[164:167], v[80:83]
    buffer_load_dwordx4 v12, s[20:23], s77 offen offset:3072 sc1 lds
    v_xor_b32 v33, s59, v33
    v_mfma_f32_16x16x32_bf16 v[68:71], v[168:171], a[172:175], v[68:71]
    v_xor_b32 v34, s59, v34
    v_exp_f32 v55, v55
    v_mfma_f32_16x16x32_bf16 v[84:87], v[172:175], a[172:175], v[84:87]
    v_xor_b32 v35, s59, v35
    v_add_f32 v52, 1.0, v52
    v_mfma_f32_16x16x32_bf16 v[72:75], v[168:171], a[180:183], v[72:75]
    buffer_store_dwordx4 v[200:203], v123, s[20:23], s96 offen offset:2048 sc1
    v_xor_b32 v36, s59, v36
    v_add_f32 v53, 1.0, v53
    v_mfma_f32_16x16x32_bf16 v[88:91], v[172:175], a[180:183], v[88:91]
    s_add_u32 m0, s101, 4096
    s_add_u32 s77, s77, 4096
    buffer_load_dwordx4 v12, s[20:23], s77 offen offset:0 sc1 lds
    v_xor_b32 v37, s59, v37
    v_mfma_f32_16x16x32_bf16 v[76:79], v[168:171], a[188:191], v[76:79]
    v_xor_b32 v38, s59, v38
    v_add_f32 v54, 1.0, v54
    v_mfma_f32_16x16x32_bf16 v[92:95], v[172:175], a[188:191], v[92:95]
    v_xor_b32 v39, s59, v39
    s_waitcnt vmcnt(16)
    v_add_f32 v55, 1.0, v55
    v_mfma_f32_16x16x32_bf16 v[64:67], v[176:179], a[196:199], v[64:67]
    ds_read_b64_tr_b16 v[128:129], v32 offset:8192
    v_rcp_f32 v52, v52
    v_mfma_f32_16x16x32_bf16 v[80:83], v[180:183], a[196:199], v[80:83]
    buffer_load_dwordx4 v12, s[20:23], s77 offen offset:1024 sc1 lds
    ds_read_b64_tr_b16 v[130:131], v32 offset:9216
    v_mfma_f32_16x16x32_bf16 v[68:71], v[176:179], a[204:207], v[68:71]
    buffer_store_dwordx4 v[204:207], v124, s[20:23], s96 offen offset:3072 sc1
    ds_read_b64_tr_b16 v[132:133], v36 offset:8192
    v_rcp_f32 v53, v53
    v_mfma_f32_16x16x32_bf16 v[84:87], v[180:183], a[204:207], v[84:87]
    ds_read_b64_tr_b16 v[134:135], v36 offset:9216
    v_rcp_f32 v54, v54
    v_mfma_f32_16x16x32_bf16 v[72:75], v[176:179], a[212:215], v[72:75]
    ds_read_b64_tr_b16 v[136:137], v33 offset:8192
    v_rcp_f32 v55, v55
    v_mfma_f32_16x16x32_bf16 v[88:91], v[180:183], a[212:215], v[88:91]
    buffer_load_dwordx4 v12, s[20:23], s77 offen offset:2048 sc1 lds
    ds_read_b64_tr_b16 v[138:139], v33 offset:9216
    v_mfma_f32_16x16x32_bf16 v[76:79], v[176:179], a[220:223], v[76:79]
    ds_read_b64_tr_b16 v[140:141], v37 offset:8192
    v_mul_f32 v228, v228, v52
    v_mfma_f32_16x16x32_bf16 v[92:95], v[180:183], a[220:223], v[92:95]
    ds_read_b64_tr_b16 v[142:143], v37 offset:9216
    v_mul_f32 v229, v229, v53
    v_mfma_f32_16x16x32_bf16 v[64:67], v[184:187], a[228:231], v[64:67]
    buffer_store_dwordx4 v[208:211], v125, s[20:23], s60 offen offset:0 sc1
    ds_read_b64_tr_b16 v[144:145], v34 offset:8192
    v_mul_f32 v230, v230, v54
    v_mfma_f32_16x16x32_bf16 v[80:83], v[188:191], a[228:231], v[80:83]
    buffer_load_dwordx4 v12, s[20:23], s77 offen offset:3072 sc1 lds
    ds_read_b64_tr_b16 v[146:147], v34 offset:9216
    v_mfma_f32_16x16x32_bf16 v[68:71], v[184:187], a[236:239], v[68:71]
    ds_read_b64_tr_b16 v[148:149], v38 offset:8192
    v_mul_f32 v231, v231, v55
    v_mfma_f32_16x16x32_bf16 v[84:87], v[188:191], a[236:239], v[84:87]
    ds_read_b64_tr_b16 v[150:151], v38 offset:9216
    v_mfma_f32_16x16x32_bf16 v[72:75], v[184:187], a[244:247], v[72:75]
    ds_read_b64_tr_b16 v[152:153], v35 offset:8192
    v_mfma_f32_16x16x32_bf16 v[88:91], v[188:191], a[244:247], v[88:91]
    ds_read_b64_tr_b16 v[154:155], v35 offset:9216
    v_mfma_f32_16x16x32_bf16 v[76:79], v[184:187], a[252:255], v[76:79]
    ds_read_b64_tr_b16 v[156:157], v39 offset:8192
    v_mfma_f32_16x16x32_bf16 v[92:95], v[188:191], a[252:255], v[92:95]
    ds_read_b64_tr_b16 v[158:159], v39 offset:9216
    s_waitcnt lgkmcnt(0)
    s_add_u32 m0, s101, 8192
    s_xor_b32 s77, s90, 40960
    s_add_u32 s77, s77, 131072
    buffer_load_dwordx4 v12, s[20:23], s77 offen offset:0 sc1 lds
    v_mfma_f32_16x16x32_bf16 v[96:99], v[128:131], a[0:3], v[240:243]
    buffer_load_dwordx4 v12, s[20:23], s77 offen offset:1024 sc1 lds
    v_mfma_f32_16x16x32_bf16 v[112:115], v[132:135], a[0:3], 0
    v_mfma_f32_16x16x32_bf16 v[100:103], v[128:131], a[8:11], v[244:247]
    buffer_load_dwordx4 v12, s[20:23], s77 offen offset:2048 sc1 lds
    ds_write_b128 v26, v[72:75] offset:0
    v_mfma_f32_16x16x32_bf16 v[116:119], v[132:135], a[8:11], 0
    v_mfma_f32_16x16x32_bf16 v[104:107], v[128:131], a[16:19], 0
    ds_write_b128 v26, v[76:79] offset:1024
    v_mfma_f32_16x16x32_bf16 v[120:123], v[132:135], a[16:19], 0
    v_mfma_f32_16x16x32_bf16 v[108:111], v[128:131], a[24:27], 0
    ds_write_b128 v25, v[80:83] offset:1024
    v_mfma_f32_16x16x32_bf16 v[124:127], v[132:135], a[24:27], 0
    v_mfma_f32_16x16x32_bf16 v[96:99], v[136:139], a[32:35], v[96:99]
    buffer_load_dwordx4 v12, s[20:23], s77 offen offset:3072 sc1 lds
    ds_write_b128 v25, v[84:87] offset:0
    v_mfma_f32_16x16x32_bf16 v[112:115], v[140:143], a[32:35], v[112:115]
    v_mfma_f32_16x16x32_bf16 v[100:103], v[136:139], a[40:43], v[100:103]
    ds_write_b128 v27, v[88:91] offset:1024
    v_mfma_f32_16x16x32_bf16 v[116:119], v[140:143], a[40:43], v[116:119]
    v_mfma_f32_16x16x32_bf16 v[104:107], v[136:139], a[48:51], v[104:107]
    s_add_u32 m0, s101, 12288
    s_add_u32 s77, s77, 4096
    buffer_load_dwordx4 v12, s[20:23], s77 offen offset:0 sc1 lds
    ds_write_b128 v27, v[92:95] offset:0
    v_mfma_f32_16x16x32_bf16 v[120:123], v[140:143], a[48:51], v[120:123]
    v_mfma_f32_16x16x32_bf16 v[108:111], v[136:139], a[56:59], v[108:111]
    v_mfma_f32_16x16x32_bf16 v[124:127], v[140:143], a[56:59], v[124:127]
    v_mfma_f32_16x16x32_bf16 v[96:99], v[144:147], a[64:67], v[96:99]
    buffer_load_dwordx4 v12, s[20:23], s77 offen offset:1024 sc1 lds
    v_mfma_f32_16x16x32_bf16 v[112:115], v[148:151], a[64:67], v[112:115]
    s_waitcnt vmcnt(19)
    ds_read_b64_tr_b16 v[160:161], v32 offset:16384
    v_mfma_f32_16x16x32_bf16 v[100:103], v[144:147], a[72:75], v[100:103]
    ds_read_b64_tr_b16 v[162:163], v32 offset:17408
    v_mfma_f32_16x16x32_bf16 v[116:119], v[148:151], a[72:75], v[116:119]
    ds_read_b64_tr_b16 v[164:165], v36 offset:16384
    s_waitcnt lgkmcnt(3)
    s_barrier
    v_mfma_f32_16x16x32_bf16 v[104:107], v[144:147], a[80:83], v[104:107]
    ds_read_b128 v[192:195], v24 offset:0
    ds_read_b128 v[196:199], v24 offset:1024
    v_mfma_f32_16x16x32_bf16 v[120:123], v[148:151], a[80:83], v[120:123]
    buffer_load_dwordx4 v12, s[20:23], s77 offen offset:2048 sc1 lds
    ds_read_b128 v[200:203], v24 offset:2048
    v_mfma_f32_16x16x32_bf16 v[108:111], v[144:147], a[88:91], v[108:111]
    ds_read_b128 v[204:207], v24 offset:3072
    ds_read_b128 v[208:211], v24 offset:4096
    v_mfma_f32_16x16x32_bf16 v[124:127], v[148:151], a[88:91], v[124:127]
    ds_read_b128 v[212:215], v24 offset:5120
    ds_read_b64_tr_b16 v[166:167], v36 offset:17408
    v_mfma_f32_16x16x32_bf16 v[96:99], v[152:155], a[96:99], v[96:99]
    ds_read_b64_tr_b16 v[168:169], v33 offset:16384
    ds_read_b64_tr_b16 v[170:171], v33 offset:17408
    v_mfma_f32_16x16x32_bf16 v[112:115], v[156:159], a[96:99], v[112:115]
    buffer_load_dwordx4 v12, s[20:23], s77 offen offset:3072 sc1 lds
    ds_read_b64_tr_b16 v[172:173], v37 offset:16384
    v_mfma_f32_16x16x32_bf16 v[100:103], v[152:155], a[104:107], v[100:103]
    ds_read_b64_tr_b16 v[174:175], v37 offset:17408
    ds_read_b64_tr_b16 v[176:177], v34 offset:16384
    v_mfma_f32_16x16x32_bf16 v[116:119], v[156:159], a[104:107], v[116:119]
    ds_read_b64_tr_b16 v[178:179], v34 offset:17408
    ds_read_b64_tr_b16 v[180:181], v38 offset:16384
    v_mfma_f32_16x16x32_bf16 v[104:107], v[152:155], a[112:115], v[104:107]
    ds_read_b64_tr_b16 v[182:183], v38 offset:17408
    ds_read_b64_tr_b16 v[184:185], v35 offset:16384
    v_mfma_f32_16x16x32_bf16 v[120:123], v[156:159], a[112:115], v[120:123]
    ds_read_b64_tr_b16 v[186:187], v35 offset:17408
    v_mfma_f32_16x16x32_bf16 v[108:111], v[152:155], a[120:123], v[108:111]
    ds_read_b64_tr_b16 v[188:189], v39 offset:16384
    ds_read_b64_tr_b16 v[190:191], v39 offset:17408
    v_mfma_f32_16x16x32_bf16 v[124:127], v[156:159], a[120:123], v[124:127]
    s_waitcnt lgkmcnt(0)
    s_add_u32 m0, s101, 16384
    s_xor_b32 s77, s90, 0
    s_add_u32 s77, s77, 262144
    buffer_load_dwordx4 v12, s[20:23], s77 offen offset:0 sc1 lds
    v_mfma_f32_16x16x32_bf16 v[96:99], v[160:163], a[4:7], v[96:99]
    buffer_load_dwordx4 v12, s[20:23], s77 offen offset:1024 sc1 lds
    s_mul_i32 s78, s65, 96
    s_add_u32 s78, s78, s66
    s_lshl_b32 s78, s78, 10
    s_add_u32 s78, s78, 0x500000
    v_add_f32 v64, v64, v192
    v_add_f32 v65, v65, v193
    v_add_f32 v66, v66, v194
    buffer_load_dwordx4 v12, s[20:23], s77 offen offset:2048 sc1 lds
    v_mfma_f32_16x16x32_bf16 v[112:115], v[164:167], a[4:7], v[112:115]
    v_add_f32 v67, v67, v195
    v_add_f32 v68, v68, v196
    v_mfma_f32_16x16x32_bf16 v[100:103], v[160:163], a[12:15], v[100:103]
    v_add_f32 v69, v69, v197
    v_add_f32 v70, v70, v198
    v_add_f32 v71, v71, v199
    v_mfma_f32_16x16x32_bf16 v[116:119], v[164:167], a[12:15], v[116:119]
    v_add_f32 v64, v64, v200
    v_add_f32 v65, v65, v201
    v_add_f32 v66, v66, v202
    v_mfma_f32_16x16x32_bf16 v[104:107], v[160:163], a[20:23], v[104:107]
    v_add_f32 v67, v67, v203
    v_add_f32 v68, v68, v204
    v_add_f32 v69, v69, v205
    v_mfma_f32_16x16x32_bf16 v[120:123], v[164:167], a[20:23], v[120:123]
    v_add_f32 v70, v70, v206
    v_add_f32 v71, v71, v207
    v_mfma_f32_16x16x32_bf16 v[108:111], v[160:163], a[28:31], v[108:111]
    v_add_f32 v64, v64, v208
    v_add_f32 v65, v65, v209
    v_mfma_f32_16x16x32_bf16 v[124:127], v[164:167], a[28:31], v[124:127]
    v_add_f32 v66, v66, v210
    v_add_f32 v67, v67, v211
    v_mfma_f32_16x16x32_bf16 v[96:99], v[168:171], a[36:39], v[96:99]
    v_add_f32 v68, v68, v212
    v_add_f32 v69, v69, v213
    v_mfma_f32_16x16x32_bf16 v[112:115], v[172:175], a[36:39], v[112:115]
    buffer_load_dwordx4 v12, s[20:23], s77 offen offset:3072 sc1 lds
    v_add_f32 v70, v70, v214
    v_mfma_f32_16x16x32_bf16 v[100:103], v[168:171], a[44:47], v[100:103]
    v_add_f32 v71, v71, v215
    v_mul_f32 v64, v64, v216
    v_mfma_f32_16x16x32_bf16 v[116:119], v[172:175], a[44:47], v[116:119]
    v_mul_f32 v65, v65, v217
    v_mul_f32 v66, v66, v218
    v_mfma_f32_16x16x32_bf16 v[104:107], v[168:171], a[52:55], v[104:107]
    v_xor_b32 v32, s59, v32
    v_xor_b32 v33, s59, v33
    v_mfma_f32_16x16x32_bf16 v[120:123], v[172:175], a[52:55], v[120:123]
    v_xor_b32 v34, s59, v34
    v_xor_b32 v35, s59, v35
    v_mfma_f32_16x16x32_bf16 v[108:111], v[168:171], a[60:63], v[108:111]
    v_xor_b32 v36, s59, v36
    v_xor_b32 v37, s59, v37
    s_add_u32 m0, s101, 20480
    s_add_u32 s77, s77, 4096
    buffer_load_dwordx4 v12, s[20:23], s77 offen offset:0 sc1 lds
    v_mfma_f32_16x16x32_bf16 v[124:127], v[172:175], a[60:63], v[124:127]
    v_xor_b32 v38, s59, v38
    v_xor_b32 v39, s59, v39
    s_waitcnt vmcnt(13)
    v_mfma_f32_16x16x32_bf16 v[96:99], v[176:179], a[68:71], v[96:99]
    ds_read_b64_tr_b16 v[128:129], v32 offset:0
    v_mul_f32 v67, v67, v219
    v_mfma_f32_16x16x32_bf16 v[112:115], v[180:183], a[68:71], v[112:115]
    buffer_load_dwordx4 v12, s[20:23], s77 offen offset:1024 sc1 lds
    ds_read_b64_tr_b16 v[130:131], v32 offset:1024
    v_mfma_f32_16x16x32_bf16 v[100:103], v[176:179], a[76:79], v[100:103]
    ds_read_b64_tr_b16 v[132:133], v36 offset:0
    v_mul_f32 v68, v68, v220
    v_mfma_f32_16x16x32_bf16 v[116:119], v[180:183], a[76:79], v[116:119]
    ds_read_b64_tr_b16 v[134:135], v36 offset:1024
    v_mul_f32 v69, v69, v221
    v_mfma_f32_16x16x32_bf16 v[104:107], v[176:179], a[84:87], v[104:107]
    ds_read_b64_tr_b16 v[136:137], v33 offset:0
    v_mul_f32 v70, v70, v222
    v_mfma_f32_16x16x32_bf16 v[120:123], v[180:183], a[84:87], v[120:123]
    buffer_load_dwordx4 v12, s[20:23], s77 offen offset:2048 sc1 lds
    ds_read_b64_tr_b16 v[138:139], v33 offset:1024
    v_mfma_f32_16x16x32_bf16 v[108:111], v[176:179], a[92:95], v[108:111]
    ds_read_b64_tr_b16 v[140:141], v37 offset:0
    v_mul_f32 v71, v71, v223
    v_mfma_f32_16x16x32_bf16 v[124:127], v[180:183], a[92:95], v[124:127]
    ds_read_b64_tr_b16 v[142:143], v37 offset:1024
    v_cvt_pk_bf16_f32 v44, v64, v65
    v_mfma_f32_16x16x32_bf16 v[96:99], v[184:187], a[100:103], v[96:99]
    ds_read_b64_tr_b16 v[144:145], v34 offset:0
    v_cvt_pk_bf16_f32 v45, v66, v67
    v_mfma_f32_16x16x32_bf16 v[112:115], v[188:191], a[100:103], v[112:115]
    buffer_load_dwordx4 v12, s[20:23], s77 offen offset:3072 sc1 lds
    ds_read_b64_tr_b16 v[146:147], v34 offset:1024
    v_mfma_f32_16x16x32_bf16 v[100:103], v[184:187], a[108:111], v[100:103]
    ds_read_b64_tr_b16 v[148:149], v38 offset:0
    v_cvt_pk_bf16_f32 v46, v68, v69
    v_mfma_f32_16x16x32_bf16 v[116:119], v[188:191], a[108:111], v[116:119]
    ds_read_b64_tr_b16 v[150:151], v38 offset:1024
    v_cvt_pk_bf16_f32 v47, v70, v71
    v_mfma_f32_16x16x32_bf16 v[104:107], v[184:187], a[116:119], v[104:107]
    ds_read_b64_tr_b16 v[152:153], v35 offset:0
    v_permlane16_swap_b32 v44, v46
    v_mfma_f32_16x16x32_bf16 v[120:123], v[188:191], a[116:119], v[120:123]
    ds_read_b64_tr_b16 v[154:155], v35 offset:1024
    v_mfma_f32_16x16x32_bf16 v[108:111], v[184:187], a[124:127], v[108:111]
    ds_read_b64_tr_b16 v[156:157], v39 offset:0
    v_permlane16_swap_b32 v45, v47
    v_mfma_f32_16x16x32_bf16 v[124:127], v[188:191], a[124:127], v[124:127]
    ds_read_b64_tr_b16 v[158:159], v39 offset:1024
    buffer_store_dwordx4 v[44:47], v255, s[20:23], s78 offen sc1
    s_waitcnt lgkmcnt(0)
    s_add_u32 m0, s101, 0
    s_xor_b32 s77, s90, 32768
    s_add_u32 s77, s77, 262144
    buffer_load_dwordx4 v12, s[20:23], s77 offen offset:0 sc1 lds
    v_mfma_f32_16x16x32_bf16 v[96:99], v[128:131], a[128:131], v[96:99]
    v_mul_f32 v52, v232, v232
    v_mul_f32 v53, v233, v233
    v_mfma_f32_16x16x32_bf16 v[112:115], v[132:135], a[128:131], v[112:115]
    buffer_load_dwordx4 v12, s[20:23], s77 offen offset:1024 sc1 lds
    v_mul_f32 v54, v234, v234
    v_mfma_f32_16x16x32_bf16 v[100:103], v[128:131], a[136:139], v[100:103]
    v_mul_f32 v55, v235, v235
    v_fma_f32 v52, v52, s92, v248
    v_mfma_f32_16x16x32_bf16 v[116:119], v[132:135], a[136:139], v[116:119]
    v_fma_f32 v53, v53, s92, v248
    v_fma_f32 v54, v54, s92, v248
    v_mfma_f32_16x16x32_bf16 v[104:107], v[128:131], a[144:147], v[104:107]
    v_fma_f32 v55, v55, s92, v248
    v_mul_f32 v52, v52, v232
    v_mfma_f32_16x16x32_bf16 v[120:123], v[132:135], a[144:147], v[120:123]
    buffer_load_dwordx4 v12, s[20:23], s77 offen offset:2048 sc1 lds
    v_mul_f32 v53, v53, v233
    v_mfma_f32_16x16x32_bf16 v[108:111], v[128:131], a[152:155], v[108:111]
    v_mul_f32 v54, v54, v234
    v_mul_f32 v55, v55, v235
    v_mfma_f32_16x16x32_bf16 v[124:127], v[132:135], a[152:155], v[124:127]
    v_exp_f32 v52, v52
    v_exp_f32 v53, v53
    v_mfma_f32_16x16x32_bf16 v[96:99], v[136:139], a[160:163], v[96:99]
    s_waitcnt vmcnt(12)
    ds_read_b64_tr_b16 v[160:161], v32 offset:8192
    v_exp_f32 v54, v54
    v_mfma_f32_16x16x32_bf16 v[112:115], v[140:143], a[160:163], v[112:115]
    buffer_load_dwordx4 v12, s[20:23], s77 offen offset:3072 sc1 lds
    ds_read_b64_tr_b16 v[162:163], v32 offset:9216
    v_mfma_f32_16x16x32_bf16 v[100:103], v[136:139], a[168:171], v[100:103]
    ds_read_b64_tr_b16 v[164:165], v36 offset:8192
    v_exp_f32 v55, v55
    v_mfma_f32_16x16x32_bf16 v[116:119], v[140:143], a[168:171], v[116:119]
    ds_read_b64_tr_b16 v[166:167], v36 offset:9216
    v_add_f32 v52, 1.0, v52
    v_mfma_f32_16x16x32_bf16 v[104:107], v[136:139], a[176:179], v[104:107]
    ds_read_b64_tr_b16 v[168:169], v33 offset:8192
    v_add_f32 v53, 1.0, v53
    v_mfma_f32_16x16x32_bf16 v[120:123], v[140:143], a[176:179], v[120:123]
    s_add_u32 m0, s101, 4096
    s_add_u32 s77, s77, 4096
    buffer_load_dwordx4 v12, s[20:23], s77 offen offset:0 sc1 lds
    ds_read_b64_tr_b16 v[170:171], v33 offset:9216
    v_mfma_f32_16x16x32_bf16 v[108:111], v[136:139], a[184:187], v[108:111]
    ds_read_b64_tr_b16 v[172:173], v37 offset:8192
    v_add_f32 v54, 1.0, v54
    v_mfma_f32_16x16x32_bf16 v[124:127], v[140:143], a[184:187], v[124:127]
    ds_read_b64_tr_b16 v[174:175], v37 offset:9216
    v_add_f32 v55, 1.0, v55
    v_mfma_f32_16x16x32_bf16 v[96:99], v[144:147], a[192:195], v[96:99]
    ds_read_b64_tr_b16 v[176:177], v34 offset:8192
    v_rcp_f32 v52, v52
    v_mfma_f32_16x16x32_bf16 v[112:115], v[148:151], a[192:195], v[112:115]
    buffer_load_dwordx4 v12, s[20:23], s77 offen offset:1024 sc1 lds
    ds_read_b64_tr_b16 v[178:179], v34 offset:9216
    v_mfma_f32_16x16x32_bf16 v[100:103], v[144:147], a[200:203], v[100:103]
    ds_read_b64_tr_b16 v[180:181], v38 offset:8192
    v_rcp_f32 v53, v53
    v_mfma_f32_16x16x32_bf16 v[116:119], v[148:151], a[200:203], v[116:119]
    ds_read_b64_tr_b16 v[182:183], v38 offset:9216
    v_rcp_f32 v54, v54
    v_mfma_f32_16x16x32_bf16 v[104:107], v[144:147], a[208:211], v[104:107]
    ds_read_b64_tr_b16 v[184:185], v35 offset:8192
    v_rcp_f32 v55, v55
    v_mfma_f32_16x16x32_bf16 v[120:123], v[148:151], a[208:211], v[120:123]
    buffer_load_dwordx4 v12, s[20:23], s77 offen offset:2048 sc1 lds
    ds_read_b64_tr_b16 v[186:187], v35 offset:9216
    v_mfma_f32_16x16x32_bf16 v[108:111], v[144:147], a[216:219], v[108:111]
    ds_read_b64_tr_b16 v[188:189], v39 offset:8192
    v_mul_f32 v232, v232, v52
    v_mfma_f32_16x16x32_bf16 v[124:127], v[148:151], a[216:219], v[124:127]
    ds_read_b64_tr_b16 v[190:191], v39 offset:9216
    v_mul_f32 v233, v233, v53
    v_mfma_f32_16x16x32_bf16 v[96:99], v[152:155], a[224:227], v[96:99]
    v_mul_f32 v234, v234, v54
    v_mul_f32 v235, v235, v55
    v_mfma_f32_16x16x32_bf16 v[112:115], v[156:159], a[224:227], v[112:115]
    buffer_load_dwordx4 v12, s[20:23], s77 offen offset:3072 sc1 lds
    v_mfma_f32_16x16x32_bf16 v[100:103], v[152:155], a[232:235], v[100:103]
    v_mfma_f32_16x16x32_bf16 v[116:119], v[156:159], a[232:235], v[116:119]
    v_mfma_f32_16x16x32_bf16 v[104:107], v[152:155], a[240:243], v[104:107]
    v_mfma_f32_16x16x32_bf16 v[120:123], v[156:159], a[240:243], v[120:123]
    v_mfma_f32_16x16x32_bf16 v[108:111], v[152:155], a[248:251], v[108:111]
    v_mfma_f32_16x16x32_bf16 v[124:127], v[156:159], a[248:251], v[124:127]
    s_lshl_b32 s78, s67, 3
    s_add_u32 s78, s78, s66
    s_lshl_b32 s78, s78, 7
    s_add_u32 s78, s78, 0
    s_add_u32 s78, s78, s97
    s_waitcnt vmcnt(8)
    v_mov_b32 v0, 0
    s_mov_b64 exec, 1
    buffer_store_dword v31, v0, s[20:23], s78 offen sc1
    s_mov_b64 exec, -1
    s_getpc_b64 s[40:41]
L_cq2:
    s_mov_b32 s42, L_code_end - L_cq2
    s_mov_b32 s43, 0x20000
    s_and_b32 s78, s65, 7
    s_lshl_b32 s78, s78, 2
    s_add_u32 s78, s78, s64
    s_lshl_b32 s78, s78, 8
    s_add_u32 s78, s78, 2048
    v_and_b32 v0, 128, v12
    buffer_load_dword v51, v0, s[40:43], s78 offen
    s_waitcnt lgkmcnt(0)
    s_add_u32 m0, s101, 8192
    s_xor_b32 s77, s90, 8192
    s_add_u32 s77, s77, 262144
    buffer_load_dwordx4 v12, s[20:23], s77 offen offset:0 sc1 lds
    v_mfma_f32_16x16x32_bf16 v[96:99], v[160:163], a[132:135], v[96:99]
    buffer_load_dwordx4 v12, s[20:23], s77 offen offset:1024 sc1 lds
    s_sub_u32 s79, 7, s66
    s_min_u32 s79, s79, s66
    s_lshl_b32 s79, s79, 1
    s_barrier
    buffer_load_dwordx4 v12, s[20:23], s77 offen offset:2048 sc1 lds
    s_and_b32 s95, s65, 24
    s_add_u32 s95, s95, s79
    s_lshl_b32 s95, s95, 10
    s_add_u32 s95, s95, 65536
    v_add_u32 v3, 65536, v12
    v_add_u32 v4, 131072, v12
    v_mfma_f32_16x16x32_bf16 v[112:115], v[164:167], a[132:135], v[112:115]
    v_lshrrev_b32 v40, 1, v251
    v_mfma_f32_16x16x32_bf16 v[100:103], v[160:163], a[140:143], v[100:103]
    v_bfe_u32 v41, v1, 2, 2
    v_lshl_add_u32 v40, v40, 3, v41
    v_mfma_f32_16x16x32_bf16 v[116:119], v[164:167], a[140:143], v[116:119]
    v_mul_u32_u24 v40, 320, v40
    v_and_b32 v41, 3, v1
    v_mfma_f32_16x16x32_bf16 v[104:107], v[160:163], a[148:151], v[104:107]
    v_lshl_add_u32 v40, v41, 4, v40
    v_and_b32 v41, 1, v251
    v_mfma_f32_16x16x32_bf16 v[120:123], v[164:167], a[148:151], v[120:123]
    buffer_load_dwordx4 v12, s[20:23], s77 offen offset:3072 sc1 lds
    v_lshl_add_u32 v40, v41, 3, v40
    s_mul_i32 s79, s67, 160
    s_add_u32 s79, s79, 139264
    v_mfma_f32_16x16x32_bf16 v[108:111], v[160:163], a[156:159], v[108:111]
    v_add_u32 v5, s79, v40
    v_bfe_u32 v41, v1, 1, 1
    v_mfma_f32_16x16x32_bf16 v[124:127], v[164:167], a[156:159], v[124:127]
    v_mul_u32_u24 v41, 10080, v41
    v_add_u32 v6, v5, v41
    v_mfma_f32_16x16x32_bf16 v[96:99], v[168:171], a[164:167], v[96:99]
    s_add_u32 m0, s101, 12288
    s_add_u32 s77, s77, 4096
    buffer_load_dwordx4 v12, s[20:23], s77 offen offset:0 sc1 lds
    v_xor_b32 v32, s59, v32
    v_mfma_f32_16x16x32_bf16 v[112:115], v[172:175], a[164:167], v[112:115]
    buffer_load_dwordx4 v12, s[20:23], s77 offen offset:1024 sc1 lds
    v_xor_b32 v33, s59, v33
    v_mfma_f32_16x16x32_bf16 v[100:103], v[168:171], a[172:175], v[100:103]
    v_xor_b32 v34, s59, v34
    v_mfma_f32_16x16x32_bf16 v[116:119], v[172:175], a[172:175], v[116:119]
    v_xor_b32 v35, s59, v35
    v_mfma_f32_16x16x32_bf16 v[104:107], v[168:171], a[180:183], v[104:107]
    buffer_load_dwordx4 v12, s[20:23], s77 offen offset:2048 sc1 lds
    v_xor_b32 v36, s59, v36
    v_mfma_f32_16x16x32_bf16 v[120:123], v[172:175], a[180:183], v[120:123]
    v_xor_b32 v37, s59, v37
    v_mfma_f32_16x16x32_bf16 v[108:111], v[168:171], a[188:191], v[108:111]
    v_xor_b32 v38, s59, v38
    v_mfma_f32_16x16x32_bf16 v[124:127], v[172:175], a[188:191], v[124:127]
    v_xor_b32 v39, s59, v39
    v_mfma_f32_16x16x32_bf16 v[96:99], v[176:179], a[196:199], v[96:99]
    buffer_load_dwordx4 v12, s[20:23], s77 offen offset:3072 sc1 lds
    ds_read_b64_tr_b16 v[128:129], v32 offset:16384
    v_mfma_f32_16x16x32_bf16 v[112:115], v[180:183], a[196:199], v[112:115]
    ds_read_b64_tr_b16 v[130:131], v32 offset:17408
    v_mfma_f32_16x16x32_bf16 v[100:103], v[176:179], a[204:207], v[100:103]
    ds_read_b64_tr_b16 v[132:133], v36 offset:16384
    v_mfma_f32_16x16x32_bf16 v[116:119], v[180:183], a[204:207], v[116:119]
    ds_read_b64_tr_b16 v[134:135], v36 offset:17408
    v_mfma_f32_16x16x32_bf16 v[104:107], v[176:179], a[212:215], v[104:107]
    ds_read_b64_tr_b16 v[136:137], v33 offset:16384
    v_mfma_f32_16x16x32_bf16 v[120:123], v[180:183], a[212:215], v[120:123]
    ds_read_b64_tr_b16 v[138:139], v33 offset:17408
    v_mfma_f32_16x16x32_bf16 v[108:111], v[176:179], a[220:223], v[108:111]
    ds_read_b64_tr_b16 v[140:141], v37 offset:16384
    v_mfma_f32_16x16x32_bf16 v[124:127], v[180:183], a[220:223], v[124:127]
    ds_read_b64_tr_b16 v[142:143], v37 offset:17408
    v_mfma_f32_16x16x32_bf16 v[96:99], v[184:187], a[228:231], v[96:99]
    ds_read_b64_tr_b16 v[144:145], v34 offset:16384
    v_mfma_f32_16x16x32_bf16 v[112:115], v[188:191], a[228:231], v[112:115]
    ds_read_b64_tr_b16 v[146:147], v34 offset:17408
    v_mfma_f32_16x16x32_bf16 v[100:103], v[184:187], a[236:239], v[100:103]
    ds_read_b64_tr_b16 v[148:149], v38 offset:16384
    v_mfma_f32_16x16x32_bf16 v[116:119], v[188:191], a[236:239], v[116:119]
    ds_read_b64_tr_b16 v[150:151], v38 offset:17408
    v_mfma_f32_16x16x32_bf16 v[104:107], v[184:187], a[244:247], v[104:107]
    ds_read_b64_tr_b16 v[152:153], v35 offset:16384
    v_mfma_f32_16x16x32_bf16 v[120:123], v[188:191], a[244:247], v[120:123]
    ds_read_b64_tr_b16 v[154:155], v35 offset:17408
    v_mfma_f32_16x16x32_bf16 v[108:111], v[184:187], a[252:255], v[108:111]
    ds_read_b64_tr_b16 v[156:157], v39 offset:16384
    v_mfma_f32_16x16x32_bf16 v[124:127], v[188:191], a[252:255], v[124:127]
    ds_read_b64_tr_b16 v[158:159], v39 offset:17408
    v_mov_b32 v0, 0
    s_mov_b64 exec, 1
    buffer_store_dword v31, v0, s[20:23], s2 offen sc1
    s_mov_b64 exec, -1
    s_waitcnt lgkmcnt(0)
    s_add_u32 m0, s101, 16384
    s_xor_b32 s77, s90, 40960
    s_add_u32 s77, s77, 262144
    buffer_load_dwordx4 v12, s[20:23], s77 offen offset:0 sc1 lds
    v_mfma_f32_16x16x32_bf16 v[64:67], v[128:131], a[0:3], v[240:243]
    buffer_load_dwordx4 v12, s[20:23], s77 offen offset:1024 sc1 lds
    v_mfma_f32_16x16x32_bf16 v[80:83], v[132:135], a[0:3], 0
    v_mfma_f32_16x16x32_bf16 v[68:71], v[128:131], a[8:11], v[244:247]
    buffer_load_dwordx4 v12, s[20:23], s77 offen offset:2048 sc1 lds
    ds_write_b128 v26, v[104:107] offset:0
    v_mfma_f32_16x16x32_bf16 v[84:87], v[132:135], a[8:11], 0
    v_mfma_f32_16x16x32_bf16 v[72:75], v[128:131], a[16:19], 0
    ds_write_b128 v26, v[108:111] offset:1024
    v_mfma_f32_16x16x32_bf16 v[88:91], v[132:135], a[16:19], 0
    v_mfma_f32_16x16x32_bf16 v[76:79], v[128:131], a[24:27], 0
    ds_write_b128 v25, v[112:115] offset:1024
    v_mfma_f32_16x16x32_bf16 v[92:95], v[132:135], a[24:27], 0
    v_mfma_f32_16x16x32_bf16 v[64:67], v[136:139], a[32:35], v[64:67]
    buffer_load_dwordx4 v12, s[20:23], s77 offen offset:3072 sc1 lds
    ds_write_b128 v25, v[116:119] offset:0
    v_mfma_f32_16x16x32_bf16 v[80:83], v[140:143], a[32:35], v[80:83]
    v_mfma_f32_16x16x32_bf16 v[68:71], v[136:139], a[40:43], v[68:71]
    ds_write_b128 v27, v[120:123] offset:1024
    v_mfma_f32_16x16x32_bf16 v[84:87], v[140:143], a[40:43], v[84:87]
    v_mfma_f32_16x16x32_bf16 v[72:75], v[136:139], a[48:51], v[72:75]
    s_add_u32 m0, s101, 20480
    s_add_u32 s77, s77, 4096
    buffer_load_dwordx4 v12, s[20:23], s77 offen offset:0 sc1 lds
    ds_write_b128 v27, v[124:127] offset:0
    v_mfma_f32_16x16x32_bf16 v[88:91], v[140:143], a[48:51], v[88:91]
    v_mfma_f32_16x16x32_bf16 v[76:79], v[136:139], a[56:59], v[76:79]
    v_mfma_f32_16x16x32_bf16 v[92:95], v[140:143], a[56:59], v[92:95]
    v_mfma_f32_16x16x32_bf16 v[64:67], v[144:147], a[64:67], v[64:67]
    buffer_load_dwordx4 v12, s[20:23], s77 offen offset:1024 sc1 lds
    v_mfma_f32_16x16x32_bf16 v[80:83], v[148:151], a[64:67], v[80:83]
    s_waitcnt vmcnt(17)
    ds_read_b64_tr_b16 v[160:161], v32 offset:0
    v_mfma_f32_16x16x32_bf16 v[68:71], v[144:147], a[72:75], v[68:71]
    ds_read_b64_tr_b16 v[162:163], v32 offset:1024
    v_mfma_f32_16x16x32_bf16 v[84:87], v[148:151], a[72:75], v[84:87]
    ds_read_b64_tr_b16 v[164:165], v36 offset:0
    s_waitcnt lgkmcnt(3)
    s_barrier
    v_mfma_f32_16x16x32_bf16 v[72:75], v[144:147], a[80:83], v[72:75]
    ds_read_b128 v[192:195], v24 offset:0
    ds_read_b128 v[196:199], v24 offset:1024
    v_mfma_f32_16x16x32_bf16 v[88:91], v[148:151], a[80:83], v[88:91]
    buffer_load_dwordx4 v12, s[20:23], s77 offen offset:2048 sc1 lds
    ds_read_b128 v[200:203], v24 offset:2048
    v_mfma_f32_16x16x32_bf16 v[76:79], v[144:147], a[88:91], v[76:79]
    ds_read_b128 v[204:207], v24 offset:3072
    ds_read_b128 v[208:211], v24 offset:4096
    v_mfma_f32_16x16x32_bf16 v[92:95], v[148:151], a[88:91], v[92:95]
    ds_read_b128 v[212:215], v24 offset:5120
    ds_read_b64_tr_b16 v[166:167], v36 offset:1024
    v_mfma_f32_16x16x32_bf16 v[64:67], v[152:155], a[96:99], v[64:67]
    ds_read_b64_tr_b16 v[168:169], v33 offset:0
    ds_read_b64_tr_b16 v[170:171], v33 offset:1024
    v_mfma_f32_16x16x32_bf16 v[80:83], v[156:159], a[96:99], v[80:83]
    buffer_load_dwordx4 v12, s[20:23], s77 offen offset:3072 sc1 lds
    ds_read_b64_tr_b16 v[172:173], v37 offset:0
    v_mfma_f32_16x16x32_bf16 v[68:71], v[152:155], a[104:107], v[68:71]
    ds_read_b64_tr_b16 v[174:175], v37 offset:1024
    ds_read_b64_tr_b16 v[176:177], v34 offset:0
    v_mfma_f32_16x16x32_bf16 v[84:87], v[156:159], a[104:107], v[84:87]
    ds_read_b64_tr_b16 v[178:179], v34 offset:1024
    ds_read_b64_tr_b16 v[180:181], v38 offset:0
    v_mfma_f32_16x16x32_bf16 v[72:75], v[152:155], a[112:115], v[72:75]
    ds_read_b64_tr_b16 v[182:183], v38 offset:1024
    ds_read_b64_tr_b16 v[184:185], v35 offset:0
    v_mfma_f32_16x16x32_bf16 v[88:91], v[156:159], a[112:115], v[88:91]
    s_add_u32 m0, s100, 98304
    s_add_u32 s77, s98, 0
    buffer_load_dwordx4 v12, s[20:23], s77 offen sc1 lds
    ds_read_b64_tr_b16 v[186:187], v35 offset:1024
    v_mfma_f32_16x16x32_bf16 v[76:79], v[152:155], a[120:123], v[76:79]
    ds_read_b64_tr_b16 v[188:189], v39 offset:0
    ds_read_b64_tr_b16 v[190:191], v39 offset:1024
    v_mfma_f32_16x16x32_bf16 v[92:95], v[156:159], a[120:123], v[92:95]
    s_add_u32 m0, s100, 102400
    s_add_u32 s77, s98, 4096
    buffer_load_dwordx4 v12, s[20:23], s77 offen sc1 lds
    s_waitcnt lgkmcnt(0)
    v_mfma_f32_16x16x32_bf16 v[64:67], v[160:163], a[4:7], v[64:67]
    s_add_u32 m0, s100, 106496
    s_add_u32 s77, s98, 8192
    buffer_load_dwordx4 v12, s[20:23], s77 offen sc1 lds
    s_mul_i32 s78, s65, 96
    s_add_u32 m0, s100, 110592
    s_add_u32 s77, s98, 12288
    buffer_load_dwordx4 v12, s[20:23], s77 offen sc1 lds
    s_add_u32 s78, s78, s66
    s_lshl_b32 s78, s78, 10
    s_add_u32 s78, s78, 0x502000
    v_add_f32 v96, v96, v192
    v_add_f32 v97, v97, v193
    v_add_f32 v98, v98, v194
    s_add_u32 m0, s100, 114688
    s_add_u32 s77, s98, 16384
    buffer_load_dwordx4 v12, s[20:23], s77 offen sc1 lds
    v_mfma_f32_16x16x32_bf16 v[80:83], v[164:167], a[4:7], v[80:83]
    v_add_f32 v99, v99, v195
    buffer_load_dword v48, v10, s[20:23], s97 offen offset:0 sc1
    v_add_f32 v100, v100, v196
    v_mfma_f32_16x16x32_bf16 v[68:71], v[160:163], a[12:15], v[68:71]
    v_add_f32 v101, v101, v197
    v_add_f32 v102, v102, v198
    v_add_f32 v103, v103, v199
    v_mfma_f32_16x16x32_bf16 v[84:87], v[164:167], a[12:15], v[84:87]
    v_add_f32 v96, v96, v200
    v_add_f32 v97, v97, v201
    v_add_f32 v98, v98, v202
    v_mfma_f32_16x16x32_bf16 v[72:75], v[160:163], a[20:23], v[72:75]
    v_add_f32 v99, v99, v203
    v_add_f32 v100, v100, v204
    v_add_f32 v101, v101, v205
    v_mfma_f32_16x16x32_bf16 v[88:91], v[164:167], a[20:23], v[88:91]
    v_add_f32 v102, v102, v206
    v_add_f32 v103, v103, v207
    v_mfma_f32_16x16x32_bf16 v[76:79], v[160:163], a[28:31], v[76:79]
    v_add_f32 v96, v96, v208
    v_add_f32 v97, v97, v209
    v_add_f32 v98, v98, v210
    v_mfma_f32_16x16x32_bf16 v[92:95], v[164:167], a[28:31], v[92:95]
    v_add_f32 v99, v99, v211
    v_add_f32 v100, v100, v212
    v_add_f32 v101, v101, v213
    v_mfma_f32_16x16x32_bf16 v[64:67], v[168:171], a[36:39], v[64:67]
    v_add_f32 v102, v102, v214
    v_add_f32 v103, v103, v215
    s_add_u32 m0, s100, 118784
    s_add_u32 s77, s98, 20480
    buffer_load_dwordx4 v12, s[20:23], s77 offen sc1 lds
    v_mfma_f32_16x16x32_bf16 v[80:83], v[172:175], a[36:39], v[80:83]
    s_add_u32 m0, s100, 122880
    s_add_u32 s77, s98, 24576
    buffer_load_dwordx4 v12, s[20:23], s77 offen sc1 lds
    v_mul_f32 v96, v96, v224
    v_mfma_f32_16x16x32_bf16 v[68:71], v[168:171], a[44:47], v[68:71]
    v_mul_f32 v97, v97, v225
    v_mul_f32 v98, v98, v226
    v_mfma_f32_16x16x32_bf16 v[84:87], v[172:175], a[44:47], v[84:87]
    v_mul_f32 v99, v99, v227
    v_mul_f32 v100, v100, v228
    v_mfma_f32_16x16x32_bf16 v[72:75], v[168:171], a[52:55], v[72:75]
    v_xor_b32 v32, s59, v32
    v_xor_b32 v33, s59, v33
    v_mfma_f32_16x16x32_bf16 v[88:91], v[172:175], a[52:55], v[88:91]
    v_xor_b32 v34, s59, v34
    v_xor_b32 v35, s59, v35
    v_mfma_f32_16x16x32_bf16 v[76:79], v[168:171], a[60:63], v[76:79]
    v_xor_b32 v36, s59, v36
    v_xor_b32 v37, s59, v37
    v_mfma_f32_16x16x32_bf16 v[92:95], v[172:175], a[60:63], v[92:95]
    v_xor_b32 v38, s59, v38
    v_xor_b32 v39, s59, v39
    s_waitcnt vmcnt(17)
    v_mfma_f32_16x16x32_bf16 v[64:67], v[176:179], a[68:71], v[64:67]
    ds_read_b64_tr_b16 v[128:129], v32 offset:8192
    v_mul_f32 v101, v101, v229
    v_mfma_f32_16x16x32_bf16 v[80:83], v[180:183], a[68:71], v[80:83]
    s_add_u32 m0, s100, 126976
    s_add_u32 s77, s98, 28672
    buffer_load_dwordx4 v12, s[20:23], s77 offen sc1 lds
    ds_read_b64_tr_b16 v[130:131], v32 offset:9216
    v_mfma_f32_16x16x32_bf16 v[68:71], v[176:179], a[76:79], v[68:71]
    ds_read_b64_tr_b16 v[132:133], v36 offset:8192
    v_mul_f32 v102, v102, v230
    v_mfma_f32_16x16x32_bf16 v[84:87], v[180:183], a[76:79], v[84:87]
    ds_read_b64_tr_b16 v[134:135], v36 offset:9216
    v_mul_f32 v103, v103, v231
    v_mfma_f32_16x16x32_bf16 v[72:75], v[176:179], a[84:87], v[72:75]
    ds_read_b64_tr_b16 v[136:137], v33 offset:8192
    v_cvt_pk_bf16_f32 v44, v96, v97
    v_mfma_f32_16x16x32_bf16 v[88:91], v[180:183], a[84:87], v[88:91]
    s_add_u32 m0, s100, 131072
    s_add_u32 s77, s98, 32768
    buffer_load_dwordx4 v12, s[20:23], s77 offen sc1 lds
    ds_read_b64_tr_b16 v[138:139], v33 offset:9216
    v_mfma_f32_16x16x32_bf16 v[76:79], v[176:179], a[92:95], v[76:79]
    ds_read_b64_tr_b16 v[140:141], v37 offset:8192
    v_cvt_pk_bf16_f32 v45, v98, v99
    v_mfma_f32_16x16x32_bf16 v[92:95], v[180:183], a[92:95], v[92:95]
    ds_read_b64_tr_b16 v[142:143], v37 offset:9216
    v_cvt_pk_bf16_f32 v46, v100, v101
    v_mfma_f32_16x16x32_bf16 v[64:67], v[184:187], a[100:103], v[64:67]
    ds_read_b64_tr_b16 v[144:145], v34 offset:8192
    v_cvt_pk_bf16_f32 v47, v102, v103
    v_mfma_f32_16x16x32_bf16 v[80:83], v[188:191], a[100:103], v[80:83]
    s_add_u32 m0, s100, 135168
    s_add_u32 s77, s98, 36864
    buffer_load_dwordx4 v12, s[20:23], s77 offen sc1 lds
    ds_read_b64_tr_b16 v[146:147], v34 offset:9216
    v_mfma_f32_16x16x32_bf16 v[68:71], v[184:187], a[108:111], v[68:71]
    ds_read_b64_tr_b16 v[148:149], v38 offset:8192
    v_min_u32 v44, -2, v44
    v_mfma_f32_16x16x32_bf16 v[84:87], v[188:191], a[108:111], v[84:87]
    ds_read_b64_tr_b16 v[150:151], v38 offset:9216
    v_min_u32 v45, -2, v45
    v_mfma_f32_16x16x32_bf16 v[72:75], v[184:187], a[116:119], v[72:75]
    ds_read_b64_tr_b16 v[152:153], v35 offset:8192
    v_min_u32 v46, -2, v46
    v_mfma_f32_16x16x32_bf16 v[88:91], v[188:191], a[116:119], v[88:91]
    s_add_u32 m0, s101, 0
    s_add_u32 s77, s98, 40960
    buffer_load_dwordx4 v12, s[20:23], s77 offen sc1 lds
    ds_read_b64_tr_b16 v[154:155], v35 offset:9216
    v_mfma_f32_16x16x32_bf16 v[76:79], v[184:187], a[124:127], v[76:79]
    ds_read_b64_tr_b16 v[156:157], v39 offset:8192
    v_min_u32 v47, -2, v47
    v_mfma_f32_16x16x32_bf16 v[92:95], v[188:191], a[124:127], v[92:95]
    ds_read_b64_tr_b16 v[158:159], v39 offset:9216
    v_permlane16_swap_b32 v44, v46
    s_waitcnt lgkmcnt(0)
    s_add_u32 m0, s101, 1024
    s_add_u32 s77, s98, 45056
    buffer_load_dwordx4 v12, s[20:23], s77 offen sc1 lds
    v_mfma_f32_16x16x32_bf16 v[64:67], v[128:131], a[128:131], v[64:67]
    v_permlane16_swap_b32 v45, v47
    buffer_store_dwordx4 v[44:47], v255, s[20:23], s78 offen sc1
    v_mfma_f32_16x16x32_bf16 v[80:83], v[132:135], a[128:131], v[80:83]
    s_add_u32 m0, s101, 2048
    s_add_u32 s77, s98, 49152
    buffer_load_dwordx4 v12, s[20:23], s77 offen sc1 lds
    v_mul_f32 v52, v236, v236
    v_mfma_f32_16x16x32_bf16 v[68:71], v[128:131], a[136:139], v[68:71]
    v_mul_f32 v53, v237, v237
    v_mul_f32 v54, v238, v238
    v_mfma_f32_16x16x32_bf16 v[84:87], v[132:135], a[136:139], v[84:87]
    v_mul_f32 v55, v239, v239
    v_fma_f32 v52, v52, s92, v248
    v_mfma_f32_16x16x32_bf16 v[72:75], v[128:131], a[144:147], v[72:75]
    s_waitcnt vmcnt(9)
L_chk_5:
    v_cmp_ne_u32 vcc, s68, v48
    s_nop 0
    s_cbranch_vccz L_ok_6
    s_cmp_eq_u32 s69, 0
    s_cbranch_scc1 L_ok_6
    s_sub_u32 s69, s69, 1
    buffer_load_dword v48, v10, s[20:23], s97 offen offset:0 sc1
    s_waitcnt vmcnt(0)
    s_branch L_chk_5
L_ok_6:
    v_fma_f32 v53, v53, s92, v248
    v_fma_f32 v54, v54, s92, v248
    v_mfma_f32_16x16x32_bf16 v[88:91], v[132:135], a[144:147], v[88:91]
    s_add_u32 m0, s101, 3072
    s_add_u32 s77, s98, 53248
    buffer_load_dwordx4 v12, s[20:23], s77 offen sc1 lds
    v_fma_f32 v55, v55, s92, v248
    v_mfma_f32_16x16x32_bf16 v[76:79], v[128:131], a[152:155], v[76:79]
    v_mul_f32 v52, v52, v236
    v_mul_f32 v53, v53, v237
    v_mfma_f32_16x16x32_bf16 v[92:95], v[132:135], a[152:155], v[92:95]
    v_mul_f32 v54, v54, v238
    v_mul_f32 v55, v55, v239
    v_mfma_f32_16x16x32_bf16 v[64:67], v[136:139], a[160:163], v[64:67]
    ds_read_b64_tr_b16 v[160:161], v32 offset:16384
    v_exp_f32 v52, v52
    v_mfma_f32_16x16x32_bf16 v[80:83], v[140:143], a[160:163], v[80:83]
    s_add_u32 m0, s101, 4096
    s_add_u32 s77, s98, 57344
    buffer_load_dwordx4 v12, s[20:23], s77 offen sc1 lds
    ds_read_b64_tr_b16 v[162:163], v32 offset:17408
    v_mfma_f32_16x16x32_bf16 v[68:71], v[136:139], a[168:171], v[68:71]
    ds_read_b64_tr_b16 v[164:165], v36 offset:16384
    buffer_load_dword v49, v11, s[20:23], s95 offen sc1
    v_exp_f32 v53, v53
    v_mfma_f32_16x16x32_bf16 v[84:87], v[140:143], a[168:171], v[84:87]
    ds_read_b64_tr_b16 v[166:167], v36 offset:17408
    v_exp_f32 v54, v54
    v_mfma_f32_16x16x32_bf16 v[72:75], v[136:139], a[176:179], v[72:75]
    ds_read_b64_tr_b16 v[168:169], v33 offset:16384
    v_exp_f32 v55, v55
    v_mfma_f32_16x16x32_bf16 v[88:91], v[140:143], a[176:179], v[88:91]
    s_add_u32 m0, s101, 5120
    s_add_u32 s77, s98, 61440
    buffer_load_dwordx4 v12, s[20:23], s77 offen sc1 lds
    ds_read_b64_tr_b16 v[170:171], v33 offset:17408
    v_mfma_f32_16x16x32_bf16 v[76:79], v[136:139], a[184:187], v[76:79]
    ds_read_b64_tr_b16 v[172:173], v37 offset:16384
    v_add_f32 v52, 1.0, v52
    v_mfma_f32_16x16x32_bf16 v[92:95], v[140:143], a[184:187], v[92:95]
    ds_read_b64_tr_b16 v[174:175], v37 offset:17408
    v_add_f32 v53, 1.0, v53
    v_mfma_f32_16x16x32_bf16 v[64:67], v[144:147], a[192:195], v[64:67]
    ds_read_b64_tr_b16 v[176:177], v34 offset:16384
    v_add_f32 v54, 1.0, v54
    v_mfma_f32_16x16x32_bf16 v[80:83], v[148:151], a[192:195], v[80:83]
    s_add_u32 m0, s101, 6144
    s_add_u32 s77, s98, 65536
    buffer_load_dwordx4 v12, s[20:23], s77 offen sc1 lds
    ds_read_b64_tr_b16 v[178:179], v34 offset:17408
    v_mfma_f32_16x16x32_bf16 v[68:71], v[144:147], a[200:203], v[68:71]
    ds_read_b64_tr_b16 v[180:181], v38 offset:16384
    v_add_f32 v55, 1.0, v55
    v_mfma_f32_16x16x32_bf16 v[84:87], v[148:151], a[200:203], v[84:87]
    ds_read_b64_tr_b16 v[182:183], v38 offset:17408
    v_rcp_f32 v52, v52
    v_mfma_f32_16x16x32_bf16 v[72:75], v[144:147], a[208:211], v[72:75]
    ds_read_b64_tr_b16 v[184:185], v35 offset:16384
    v_rcp_f32 v53, v53
    v_mfma_f32_16x16x32_bf16 v[88:91], v[148:151], a[208:211], v[88:91]
    s_add_u32 m0, s101, 7168
    s_add_u32 s77, s98, 69632
    buffer_load_dwordx4 v12, s[20:23], s77 offen sc1 lds
    ds_read_b64_tr_b16 v[186:187], v35 offset:17408
    v_mfma_f32_16x16x32_bf16 v[76:79], v[144:147], a[216:219], v[76:79]
    ds_read_b64_tr_b16 v[188:189], v39 offset:16384
    v_rcp_f32 v54, v54
    v_mfma_f32_16x16x32_bf16 v[92:95], v[148:151], a[216:219], v[92:95]
    ds_read_b64_tr_b16 v[190:191], v39 offset:17408
    v_rcp_f32 v55, v55
    v_mfma_f32_16x16x32_bf16 v[64:67], v[152:155], a[224:227], v[64:67]
    v_mul_f32 v236, v236, v52
    v_mul_f32 v237, v237, v53
    v_mfma_f32_16x16x32_bf16 v[80:83], v[156:159], a[224:227], v[80:83]
    s_add_u32 m0, s101, 8192
    s_add_u32 s77, s98, 73728
    buffer_load_dwordx4 v12, s[20:23], s77 offen sc1 lds
    v_mul_f32 v238, v238, v54
    v_mfma_f32_16x16x32_bf16 v[68:71], v[152:155], a[232:235], v[68:71]
    s_add_u32 m0, s101, 9216
    s_add_u32 s77, s98, 77824
    buffer_load_dwordx4 v12, s[20:23], s77 offen sc1 lds
    v_mul_f32 v239, v239, v55
    v_mfma_f32_16x16x32_bf16 v[84:87], v[156:159], a[232:235], v[84:87]
    v_mfma_f32_16x16x32_bf16 v[72:75], v[152:155], a[240:243], v[72:75]
    s_add_u32 s77, s91, 0
    buffer_load_dwordx4 a[0:3], v12, s[20:23], s77 offen offset:0 sc1
    v_mfma_f32_16x16x32_bf16 v[88:91], v[156:159], a[240:243], v[88:91]
    v_mfma_f32_16x16x32_bf16 v[76:79], v[152:155], a[248:251], v[76:79]
    v_mfma_f32_16x16x32_bf16 v[92:95], v[156:159], a[248:251], v[92:95]
    s_waitcnt lgkmcnt(0)
    v_mfma_f32_16x16x32_bf16 v[64:67], v[160:163], a[132:135], v[64:67]
    s_mul_i32 s79, s64, 2560
    s_add_u32 s79, s79, 98304
    v_add_u32 v22, s79, v12
    s_barrier
    v_mul_u32_u24 v40, 160, v252
    v_mfma_f32_16x16x32_bf16 v[80:83], v[164:167], a[132:135], v[80:83]
    buffer_load_dwordx4 a[8:11], v12, s[20:23], s77 offen offset:1024 sc1
    v_lshl_add_u32 v40, v251, 3, v40
    v_mfma_f32_16x16x32_bf16 v[68:71], v[160:163], a[140:143], v[68:71]
    v_add_u32 v21, s79, v40
    s_mov_b32 s79, 81760
    v_mul_u32_u24 v40, 6554, v1
    v_mfma_f32_16x16x32_bf16 v[84:87], v[164:167], a[140:143], v[84:87]
    v_lshrrev_b32 v41, 16, v40
    v_mad_u32_u24 v7, v41, s79, v12
    v_mfma_f32_16x16x32_bf16 v[72:75], v[160:163], a[148:151], v[72:75]
    v_add_u32 v40, 419456, v40
    v_lshrrev_b32 v41, 16, v40
    v_mfma_f32_16x16x32_bf16 v[88:91], v[164:167], a[148:151], v[88:91]
    buffer_load_dwordx4 a[16:19], v12, s[20:23], s77 offen offset:2048 sc1
    v_mad_u32_u24 v8, v41, s79, v12
    v_mfma_f32_16x16x32_bf16 v[76:79], v[160:163], a[156:159], v[76:79]
    v_add_u32 v40, 419456, v40
    v_lshrrev_b32 v41, 16, v40
    v_mfma_f32_16x16x32_bf16 v[92:95], v[164:167], a[156:159], v[92:95]
    buffer_load_dwordx4 a[24:27], v12, s[20:23], s77 offen offset:3072 sc1
    v_mad_u32_u24 v9, v41, s79, v12
    s_add_u32 s77, s91, 4096
    buffer_load_dwordx4 a[32:35], v12, s[20:23], s77 offen offset:0 sc1
    s_lshl_b32 s96, s94, 5
    s_add_u32 s96, s96, s67
    s_lshl_b32 s96, s96, 5
    s_add_u32 s96, s96, s65
    s_mul_i32 s96, s96, 1280
    s_mul_i32 s79, s66, 160
    s_add_u32 s96, s96, s79
    v_mfma_f32_16x16x32_bf16 v[64:67], v[168:171], a[164:167], v[64:67]
    v_mfma_f32_16x16x32_bf16 v[80:83], v[172:175], a[164:167], v[80:83]
    v_mfma_f32_16x16x32_bf16 v[68:71], v[168:171], a[172:175], v[68:71]
    buffer_load_dwordx4 a[40:43], v12, s[20:23], s77 offen offset:1024 sc1
    v_mfma_f32_16x16x32_bf16 v[84:87], v[172:175], a[172:175], v[84:87]
    v_mfma_f32_16x16x32_bf16 v[72:75], v[168:171], a[180:183], v[72:75]
    v_mfma_f32_16x16x32_bf16 v[88:91], v[172:175], a[180:183], v[88:91]
    v_mfma_f32_16x16x32_bf16 v[76:79], v[168:171], a[188:191], v[76:79]
    buffer_load_dwordx4 a[48:51], v12, s[20:23], s77 offen offset:2048 sc1
    v_mfma_f32_16x16x32_bf16 v[92:95], v[172:175], a[188:191], v[92:95]
    v_mfma_f32_16x16x32_bf16 v[64:67], v[176:179], a[196:199], v[64:67]
    v_mfma_f32_16x16x32_bf16 v[80:83], v[180:183], a[196:199], v[80:83]
    v_mfma_f32_16x16x32_bf16 v[68:71], v[176:179], a[204:207], v[68:71]
    buffer_load_dwordx4 a[56:59], v12, s[20:23], s77 offen offset:3072 sc1
    v_mfma_f32_16x16x32_bf16 v[84:87], v[180:183], a[204:207], v[84:87]
    v_mfma_f32_16x16x32_bf16 v[72:75], v[176:179], a[212:215], v[72:75]
    v_mfma_f32_16x16x32_bf16 v[88:91], v[180:183], a[212:215], v[88:91]
    v_mfma_f32_16x16x32_bf16 v[76:79], v[176:179], a[220:223], v[76:79]
    s_add_u32 m0, s101, 10240
    s_add_u32 s77, s98, 81920
    buffer_load_dwordx4 v12, s[20:23], s77 offen sc1 lds
    v_mfma_f32_16x16x32_bf16 v[92:95], v[180:183], a[220:223], v[92:95]
    v_mfma_f32_16x16x32_bf16 v[64:67], v[184:187], a[228:231], v[64:67]
    v_mfma_f32_16x16x32_bf16 v[80:83], v[188:191], a[228:231], v[80:83]
    s_add_u32 m0, s101, 11264
    s_add_u32 s77, s98, 86016
    buffer_load_dwordx4 v12, s[20:23], s77 offen sc1 lds
    v_mfma_f32_16x16x32_bf16 v[68:71], v[184:187], a[236:239], v[68:71]
    v_mfma_f32_16x16x32_bf16 v[84:87], v[188:191], a[236:239], v[84:87]
    v_mfma_f32_16x16x32_bf16 v[72:75], v[184:187], a[244:247], v[72:75]
    v_mfma_f32_16x16x32_bf16 v[88:91], v[188:191], a[244:247], v[88:91]
    v_mfma_f32_16x16x32_bf16 v[76:79], v[184:187], a[252:255], v[76:79]
    v_mfma_f32_16x16x32_bf16 v[92:95], v[188:191], a[252:255], v[92:95]
    s_add_u32 s77, s91, 8192
    buffer_load_dwordx4 v[148:151], v12, s[20:23], s77 offen offset:0 sc1
    s_nop 2
    ds_write_b128 v26, v[72:75] offset:0
    s_nop 0
    ds_write_b128 v26, v[76:79] offset:1024
    ds_write_b128 v25, v[80:83] offset:1024
    ds_write_b128 v25, v[84:87] offset:0
    ds_write_b128 v27, v[88:91] offset:1024
    ds_write_b128 v27, v[92:95] offset:0
    s_mul_i32 s78, s65, 96
    s_add_u32 s78, s78, s66
    s_lshl_b32 s78, s78, 10
    s_add_u32 s78, s78, 0x504000
    s_waitcnt vmcnt(16)
L_chk_7:
    v_cmp_ne_u32 vcc, s68, v49
    s_nop 0
    s_cbranch_vccz L_ok_8
    s_cmp_eq_u32 s69, 0
    s_cbranch_scc1 L_ok_8
    s_sub_u32 s69, s69, 1
    buffer_load_dword v49, v11, s[20:23], s95 offen sc1
    s_waitcnt vmcnt(0)
    s_branch L_chk_7
L_ok_8:
    buffer_load_dwordx4 v[152:155], v12, s[20:23], s77 offen offset:1024 sc1
    s_waitcnt lgkmcnt(0)
    s_barrier
    buffer_load_dwordx4 v[156:159], v12, s[20:23], s77 offen offset:2048 sc1
    ds_read_b128 v[192:195], v24 offset:0
    ds_read_b128 v[196:199], v24 offset:1024
    ds_read_b128 v[200:203], v24 offset:2048
    ds_read_b128 v[204:207], v24 offset:3072
    ds_read_b128 v[208:211], v24 offset:4096
    ds_read_b128 v[212:215], v24 offset:5120
    buffer_load_dwordx4 v[180:183], v12, s[20:23], s77 offen offset:3072 sc1
    s_waitcnt lgkmcnt(5)
    v_pk_add_f32 v[64:65], v[64:65], v[192:193]
    v_pk_add_f32 v[66:67], v[66:67], v[194:195]
    s_waitcnt lgkmcnt(4)
    v_pk_add_f32 v[68:69], v[68:69], v[196:197]
    s_add_u32 s77, s91, 12288
    buffer_load_dwordx4 v[184:187], v12, s[20:23], s77 offen offset:0 sc1
    v_pk_add_f32 v[70:71], v[70:71], v[198:199]
    s_waitcnt lgkmcnt(3)
    v_pk_add_f32 v[64:65], v[64:65], v[200:201]
    v_pk_add_f32 v[66:67], v[66:67], v[202:203]
    s_waitcnt lgkmcnt(2)
    v_pk_add_f32 v[68:69], v[68:69], v[204:205]
    v_pk_add_f32 v[70:71], v[70:71], v[206:207]
    s_waitcnt lgkmcnt(1)
    v_pk_add_f32 v[64:65], v[64:65], v[208:209]
    v_pk_add_f32 v[66:67], v[66:67], v[210:211]
    s_waitcnt lgkmcnt(0)
    v_pk_add_f32 v[68:69], v[68:69], v[212:213]
    buffer_load_dwordx4 v[188:191], v12, s[20:23], s77 offen offset:1024 sc1
    v_pk_add_f32 v[70:71], v[70:71], v[214:215]
    v_pk_mul_f32 v[64:65], v[64:65], v[232:233]
    v_pk_mul_f32 v[66:67], v[66:67], v[234:235]
    v_pk_mul_f32 v[68:69], v[68:69], v[236:237]
    v_pk_mul_f32 v[70:71], v[70:71], v[238:239]
    v_cvt_pk_bf16_f32 v44, v64, v65
    v_cvt_pk_bf16_f32 v45, v66, v67
    v_cvt_pk_bf16_f32 v46, v68, v69
    v_cvt_pk_bf16_f32 v47, v70, v71
    v_min_u32 v44, -2, v44
    v_min_u32 v45, -2, v45
    v_min_u32 v46, -2, v46
    buffer_load_dwordx4 v[240:243], v12, s[20:23], s77 offen offset:2048 sc1
    v_min_u32 v47, -2, v47
    v_permlane16_swap_b32 v44, v46
    s_nop 0
    v_permlane16_swap_b32 v45, v47
    buffer_load_dwordx4 v[244:247], v12, s[20:23], s77 offen offset:3072 sc1
    buffer_store_dwordx4 v[44:47], v255, s[20:23], s78 offen sc1
    s_waitcnt vmcnt(11)
    s_barrier
    ds_read_b128 a[64:67], v3 offset:32768
    ds_read_b128 a[68:71], v3 offset:33792
    ds_read_b128 a[72:75], v3 offset:34816
    ds_read_b128 a[76:79], v3 offset:35840
    ds_read_b128 a[80:83], v3 offset:36864
    ds_read_b128 a[84:87], v3 offset:37888
    ds_read_b128 a[88:91], v3 offset:38912
    s_add_u32 m0, s101, 12288
    s_add_u32 s77, s98, 90112
    buffer_load_dwordx4 v12, s[20:23], s77 offen sc1 lds
    ds_read_b128 a[92:95], v3 offset:39936
    ds_read_b128 a[96:99], v3 offset:40960
    ds_read_b128 a[100:103], v3 offset:41984
    v_sub_f32 v28, 1.0, v29
    s_waitcnt lgkmcnt(5)
    v_mfma_f32_16x16x32_bf16 v[64:67], a[64:67], a[0:3], 0
    s_mul_i32 s77, s64, 5120
    s_add_u32 m0, s77, 139264
    s_add_u32 s77, s99, 0
    buffer_load_dwordx4 v12, s[20:23], s77 offen sc1 lds
    ds_read_b128 a[104:107], v3 offset:43008
    v_mfma_f32_16x16x32_bf16 v[68:71], a[68:71], a[0:3], 0
    ds_read_b128 a[108:111], v3 offset:44032
    v_mfma_f32_16x16x32_bf16 v[72:75], a[72:75], a[0:3], 0
    ds_read_b128 a[112:115], v3 offset:45056
    v_mfma_f32_16x16x32_bf16 v[76:79], a[76:79], a[0:3], 0
    ds_read_b128 a[116:119], v3 offset:46080
    v_mfma_f32_16x16x32_bf16 v[80:83], a[80:83], a[0:3], 0
    s_add_u32 m0, s101, 13312
    s_add_u32 s77, s98, 94208
    buffer_load_dwordx4 v12, s[20:23], s77 offen sc1 lds
    ds_read_b128 a[120:123], v3 offset:47104
    s_waitcnt lgkmcnt(5)
    v_mfma_f32_16x16x32_bf16 v[64:67], a[84:87], a[8:11], v[64:67]
    ds_read_b128 a[124:127], v3 offset:48128
    v_mfma_f32_16x16x32_bf16 v[68:71], a[88:91], a[8:11], v[68:71]
    ds_read_b128 a[128:131], v3 offset:49152
    v_mfma_f32_16x16x32_bf16 v[72:75], a[92:95], a[8:11], v[72:75]
    s_mul_i32 s77, s64, 5120
    s_add_u32 m0, s77, 140288
    s_add_u32 s77, s99, 1024
    buffer_load_dwordx4 v12, s[20:23], s77 offen sc1 lds
    ds_read_b128 a[132:135], v3 offset:50176
    v_mfma_f32_16x16x32_bf16 v[76:79], a[96:99], a[8:11], v[76:79]
    ds_read_b128 a[136:139], v3 offset:51200
    v_mfma_f32_16x16x32_bf16 v[80:83], a[100:103], a[8:11], v[80:83]
    ds_read_b128 a[140:143], v3 offset:52224
    s_waitcnt lgkmcnt(5)
    v_mfma_f32_16x16x32_bf16 v[64:67], a[104:107], a[16:19], v[64:67]
    s_add_u32 m0, s101, 14336
    s_add_u32 s77, s98, 98304
    buffer_load_dwordx4 v12, s[20:23], s77 offen sc1 lds
    ds_read_b128 a[64:67], v3 offset:53248
    v_mfma_f32_16x16x32_bf16 v[68:71], a[108:111], a[16:19], v[68:71]
    ds_read_b128 a[68:71], v3 offset:54272
    v_mfma_f32_16x16x32_bf16 v[72:75], a[112:115], a[16:19], v[72:75]
    ds_read_b128 a[72:75], v3 offset:55296
    v_mfma_f32_16x16x32_bf16 v[76:79], a[116:119], a[16:19], v[76:79]
    ds_read_b128 a[76:79], v3 offset:56320
    v_mfma_f32_16x16x32_bf16 v[80:83], a[120:123], a[16:19], v[80:83]
    s_mul_i32 s77, s64, 5120
    s_add_u32 m0, s77, 141312
    s_add_u32 s77, s99, 2048
    buffer_load_dwordx4 v12, s[20:23], s77 offen sc1 lds
    ds_read_b128 a[80:83], v3 offset:57344
    s_waitcnt lgkmcnt(5)
    v_mfma_f32_16x16x32_bf16 v[64:67], a[124:127], a[24:27], v[64:67]
    ds_read_b128 a[84:87], v3 offset:58368
    v_mfma_f32_16x16x32_bf16 v[68:71], a[128:131], a[24:27], v[68:71]
    ds_read_b128 a[88:91], v3 offset:59392
    v_mfma_f32_16x16x32_bf16 v[72:75], a[132:135], a[24:27], v[72:75]
    s_add_u32 m0, s101, 15360
    s_add_u32 s77, s98, 102400
    buffer_load_dwordx4 v12, s[20:23], s77 offen sc1 lds
    ds_read_b128 a[92:95], v3 offset:60416
    v_mfma_f32_16x16x32_bf16 v[76:79], a[136:139], a[24:27], v[76:79]
    ds_read_b128 a[96:99], v3 offset:61440
    v_mfma_f32_16x16x32_bf16 v[80:83], a[140:143], a[24:27], v[80:83]
    ds_read_b128 a[100:103], v3 offset:62464
    s_waitcnt lgkmcnt(5)
    v_mfma_f32_16x16x32_bf16 v[64:67], a[64:67], a[32:35], v[64:67]
    ds_read_b128 a[104:107], v3 offset:63488
    s_waitcnt vmcnt(15)
    v_max3_u32 v40, v148, v149, v150
    v_mfma_f32_16x16x32_bf16 v[68:71], a[68:71], a[32:35], v[68:71]
    ds_read_b128 a[108:111], v3 offset:64512
    v_max_u32 v40, v40, v151
    v_mfma_f32_16x16x32_bf16 v[72:75], a[72:75], a[32:35], v[72:75]
    ds_read_b128 a[112:115], v4 offset:0
    s_waitcnt vmcnt(14)
    v_max3_u32 v40, v40, v152, v153
    v_mfma_f32_16x16x32_bf16 v[76:79], a[76:79], a[32:35], v[76:79]
    ds_read_b128 a[116:119], v4 offset:1024
    v_max3_u32 v40, v40, v154, v155
    v_mfma_f32_16x16x32_bf16 v[80:83], a[80:83], a[32:35], v[80:83]
    s_mul_i32 s77, s64, 5120
    s_add_u32 m0, s77, 142336
    s_add_u32 s77, s99, 3072
    buffer_load_dwordx4 v12, s[20:23], s77 offen sc1 lds
    ds_read_b128 a[120:123], v4 offset:2048
    s_waitcnt lgkmcnt(5)
    v_mfma_f32_16x16x32_bf16 v[64:67], a[84:87], a[40:43], v[64:67]
    ds_read_b128 a[124:127], v4 offset:3072
    s_waitcnt vmcnt(14)
    v_max3_u32 v40, v40, v156, v157
    v_mfma_f32_16x16x32_bf16 v[68:71], a[88:91], a[40:43], v[68:71]
    ds_read_b128 a[128:131], v4 offset:4096
    v_max3_u32 v40, v40, v158, v159
    v_mfma_f32_16x16x32_bf16 v[72:75], a[92:95], a[40:43], v[72:75]
    ds_read_b128 a[132:135], v4 offset:5120
    s_waitcnt vmcnt(13)
    v_max3_u32 v40, v40, v180, v181
    v_mfma_f32_16x16x32_bf16 v[76:79], a[96:99], a[40:43], v[76:79]
    ds_read_b128 a[136:139], v4 offset:6144
    v_max3_u32 v40, v40, v182, v183
    v_mfma_f32_16x16x32_bf16 v[80:83], a[100:103], a[40:43], v[80:83]
    s_add_u32 m0, s101, 16384
    s_add_u32 s77, s98, 106496
    buffer_load_dwordx4 v12, s[20:23], s77 offen sc1 lds
    ds_read_b128 a[140:143], v4 offset:7168
    s_waitcnt lgkmcnt(5)
    v_mfma_f32_16x16x32_bf16 v[64:67], a[104:107], a[48:51], v[64:67]
    ds_read_b128 a[64:67], v12 offset:0
    s_waitcnt vmcnt(13)
    v_max3_u32 v40, v40, v184, v185
    v_mfma_f32_16x16x32_bf16 v[68:71], a[108:111], a[48:51], v[68:71]
    ds_read_b128 a[68:71], v12 offset:24576
    v_max3_u32 v40, v40, v186, v187
    v_mfma_f32_16x16x32_bf16 v[72:75], a[112:115], a[48:51], v[72:75]
    ds_read_b128 a[72:75], v12 offset:49152
    s_waitcnt vmcnt(12)
    v_max3_u32 v40, v40, v188, v189
    v_mfma_f32_16x16x32_bf16 v[76:79], a[116:119], a[48:51], v[76:79]
    ds_read_b128 a[76:79], v3 offset:8192
    v_max3_u32 v40, v40, v190, v191
    v_mfma_f32_16x16x32_bf16 v[80:83], a[120:123], a[48:51], v[80:83]
    s_mul_i32 s77, s64, 5120
    s_add_u32 m0, s77, 143360
    s_add_u32 s77, s99, 4096
    buffer_load_dwordx4 v12, s[20:23], s77 offen sc1 lds
    ds_read_b128 a[80:83], v12 offset:1024
    s_waitcnt lgkmcnt(5)
    v_mfma_f32_16x16x32_bf16 v[64:67], a[124:127], a[56:59], v[64:67]
    ds_read_b128 a[84:87], v12 offset:25600
    s_waitcnt vmcnt(12)
    v_max3_u32 v40, v40, v240, v241
    v_mfma_f32_16x16x32_bf16 v[68:71], a[128:131], a[56:59], v[68:71]
    ds_read_b128 a[88:91], v12 offset:50176
    v_max3_u32 v40, v40, v242, v243
    v_mfma_f32_16x16x32_bf16 v[72:75], a[132:135], a[56:59], v[72:75]
    ds_read_b128 a[92:95], v3 offset:9216
    s_waitcnt vmcnt(11)
    v_max3_u32 v40, v40, v244, v245
    v_mfma_f32_16x16x32_bf16 v[76:79], a[136:139], a[56:59], v[76:79]
    ds_read_b128 a[96:99], v12 offset:2048
    v_max3_u32 v40, v40, v246, v247
    v_mfma_f32_16x16x32_bf16 v[80:83], a[140:143], a[56:59], v[80:83]
    ds_read_b128 a[100:103], v12 offset:26624
L_chk_9:
    v_cmp_eq_u32 vcc, -1, v40
    s_nop 0
    s_cbranch_vccz L_ok_10
    s_cmp_eq_u32 s69, 0
    s_cbranch_scc1 L_ok_10
    s_sub_u32 s69, s69, 1
    s_add_u32 s79, s91, 8192
    buffer_load_dwordx4 v[148:151], v12, s[20:23], s79 offen offset:0 sc1
    buffer_load_dwordx4 v[152:155], v12, s[20:23], s79 offen offset:1024 sc1
    buffer_load_dwordx4 v[156:159], v12, s[20:23], s79 offen offset:2048 sc1
    buffer_load_dwordx4 v[180:183], v12, s[20:23], s79 offen offset:3072 sc1
    s_add_u32 s79, s91, 12288
    buffer_load_dwordx4 v[184:187], v12, s[20:23], s79 offen offset:0 sc1
    buffer_load_dwordx4 v[188:191], v12, s[20:23], s79 offen offset:1024 sc1
    buffer_load_dwordx4 v[240:243], v12, s[20:23], s79 offen offset:2048 sc1
    buffer_load_dwordx4 v[244:247], v12, s[20:23], s79 offen offset:3072 sc1
    s_waitcnt vmcnt(0)
    v_max3_u32 v40, v148, v149, v150
    v_max_u32 v40, v40, v151
    v_max3_u32 v40, v40, v152, v153
    v_max3_u32 v40, v40, v154, v155
    v_max3_u32 v40, v40, v156, v157
    v_max3_u32 v40, v40, v158, v159
    v_max3_u32 v40, v40, v180, v181
    v_max3_u32 v40, v40, v182, v183
    v_max3_u32 v40, v40, v184, v185
    v_max3_u32 v40, v40, v186, v187
    v_max3_u32 v40, v40, v188, v189
    v_max3_u32 v40, v40, v190, v191
    v_max3_u32 v40, v40, v240, v241
    v_max3_u32 v40, v40, v242, v243
    v_max3_u32 v40, v40, v244, v245
    v_max3_u32 v40, v40, v246, v247
    s_branch L_chk_9
L_ok_10:
    s_waitcnt lgkmcnt(5)
    v_mfma_f32_16x16x32_bf16 v[64:67], a[64:67], v[148:151], v[64:67]
    s_add_u32 m0, s101, 17408
    s_add_u32 s77, s98, 110592
    buffer_load_dwordx4 v12, s[20:23], s77 offen sc1 lds
    ds_read_b128 a[104:107], v12 offset:51200
    v_mfma_f32_16x16x32_bf16 v[68:71], a[68:71], v[148:151], v[68:71]
    s_add_u32 m0, s101, 18432
    s_add_u32 s77, s98, 114688
    buffer_load_dwordx4 v12, s[20:23], s77 offen sc1 lds
    ds_read_b128 a[108:111], v3 offset:10240
    v_mfma_f32_16x16x32_bf16 v[72:75], a[72:75], v[148:151], v[72:75]
    ds_read_b128 a[112:115], v12 offset:3072
    v_mfma_f32_16x16x32_bf16 v[76:79], a[76:79], v[148:151], v[76:79]
    s_add_u32 m0, s101, 19456
    s_add_u32 s77, s98, 118784
    buffer_load_dwordx4 v12, s[20:23], s77 offen sc1 lds
    ds_read_b128 a[116:119], v12 offset:27648
    v_mfma_f32_16x16x32_bf16 v[80:83], a[80:83], v[148:151], v[80:83]
    ds_read_b128 a[120:123], v12 offset:52224
    s_waitcnt lgkmcnt(5)
    v_mfma_f32_16x16x32_bf16 v[64:67], a[84:87], v[152:155], v[64:67]
    ds_read_b128 a[124:127], v3 offset:11264
    v_mfma_f32_16x16x32_bf16 v[68:71], a[88:91], v[152:155], v[68:71]
    ds_read_b128 a[128:131], v12 offset:4096
    v_mfma_f32_16x16x32_bf16 v[72:75], a[92:95], v[152:155], v[72:75]
    ds_read_b128 a[132:135], v12 offset:28672
    v_mfma_f32_16x16x32_bf16 v[76:79], a[96:99], v[152:155], v[76:79]
    ds_read_b128 a[136:139], v12 offset:53248
    v_mfma_f32_16x16x32_bf16 v[80:83], a[100:103], v[152:155], v[80:83]
    ds_read_b128 a[140:143], v3 offset:12288
    s_waitcnt lgkmcnt(5)
    v_mfma_f32_16x16x32_bf16 v[64:67], a[104:107], v[156:159], v[64:67]
    ds_read_b128 a[64:67], v12 offset:5120
    v_mfma_f32_16x16x32_bf16 v[68:71], a[108:111], v[156:159], v[68:71]
    ds_read_b128 a[68:71], v12 offset:29696
    v_mfma_f32_16x16x32_bf16 v[72:75], a[112:115], v[156:159], v[72:75]
    ds_read_b128 a[72:75], v12 offset:54272
    v_mfma_f32_16x16x32_bf16 v[76:79], a[116:119], v[156:159], v[76:79]
    ds_read_b128 a[76:79], v3 offset:13312
    v_mfma_f32_16x16x32_bf16 v[80:83], a[120:123], v[156:159], v[80:83]
    ds_read_b128 a[80:83], v12 offset:6144
    s_waitcnt lgkmcnt(5)
    v_mfma_f32_16x16x32_bf16 v[64:67], a[124:127], v[180:183], v[64:67]
    ds_read_b128 a[84:87], v12 offset:30720
    v_mfma_f32_16x16x32_bf16 v[68:71], a[128:131], v[180:183], v[68:71]
    ds_read_b128 a[88:91], v12 offset:55296
    v_mfma_f32_16x16x32_bf16 v[72:75], a[132:135], v[180:183], v[72:75]
    ds_read_b128 a[92:95], v3 offset:14336
    v_mfma_f32_16x16x32_bf16 v[76:79], a[136:139], v[180:183], v[76:79]
    ds_read_b128 a[96:99], v12 offset:7168
    v_mfma_f32_16x16x32_bf16 v[80:83], a[140:143], v[180:183], v[80:83]
    ds_read_b128 a[100:103], v12 offset:31744
    s_waitcnt lgkmcnt(5)
    v_mfma_f32_16x16x32_bf16 v[64:67], a[64:67], v[184:187], v[64:67]
    ds_read_b128 a[104:107], v12 offset:56320
    v_mfma_f32_16x16x32_bf16 v[68:71], a[68:71], v[184:187], v[68:71]
    ds_read_b128 a[108:111], v3 offset:15360
    v_mfma_f32_16x16x32_bf16 v[72:75], a[72:75], v[184:187], v[72:75]
    ds_read_b128 a[112:115], v12 offset:8192
    v_mfma_f32_16x16x32_bf16 v[76:79], a[76:79], v[184:187], v[76:79]
    ds_read_b128 a[116:119], v12 offset:32768
    v_mfma_f32_16x16x32_bf16 v[80:83], a[80:83], v[184:187], v[80:83]
    ds_read_b128 a[120:123], v12 offset:57344
    s_waitcnt vmcnt(0)
    s_barrier
    s_add_u32 s77, s91, 16384
    buffer_load_dwordx4 v[192:195], v12, s[20:23], s77 offen offset:0 sc1
    s_waitcnt lgkmcnt(5)
    v_mfma_f32_16x16x32_bf16 v[64:67], a[84:87], v[188:191], v[64:67]
    ds_read_b128 a[124:127], v3 offset:16384
    ds_read_b64_tr_b16 a[144:145], v5 offset:0
    ds_read_b64_tr_b16 a[146:147], v5 offset:1280
    v_mfma_f32_16x16x32_bf16 v[68:71], a[88:91], v[188:191], v[68:71]
    ds_read_b128 a[128:131], v12 offset:9216
    ds_read_b64_tr_b16 a[148:149], v5 offset:64
    ds_read_b64_tr_b16 a[150:151], v5 offset:1344
    v_mfma_f32_16x16x32_bf16 v[72:75], a[92:95], v[188:191], v[72:75]
    ds_read_b128 a[132:135], v12 offset:33792
    ds_read_b64_tr_b16 a[152:153], v6 offset:128
    v_mfma_f32_16x16x32_bf16 v[76:79], a[96:99], v[188:191], v[76:79]
    ds_read_b128 a[136:139], v12 offset:58368
    ds_read_b64_tr_b16 a[154:155], v6 offset:1408
    v_mfma_f32_16x16x32_bf16 v[80:83], a[100:103], v[188:191], v[80:83]
    ds_read_b128 a[140:143], v3 offset:17408
    buffer_load_dwordx4 v[196:199], v12, s[20:23], s77 offen offset:1024 sc1
    ds_read_b64_tr_b16 a[156:157], v5 offset:10272
    s_waitcnt lgkmcnt(12)
    v_mfma_f32_16x16x32_bf16 v[64:67], a[104:107], v[240:243], v[64:67]
    ds_read_b128 a[64:67], v12 offset:10240
    ds_read_b64_tr_b16 a[158:159], v5 offset:11552
    ds_read_b64_tr_b16 a[160:161], v5 offset:10336
    v_mfma_f32_16x16x32_bf16 v[68:71], a[108:111], v[240:243], v[68:71]
    ds_read_b128 a[68:71], v12 offset:34816
    ds_read_b64_tr_b16 a[162:163], v5 offset:11616
    ds_read_b64_tr_b16 a[164:165], v5 offset:5120
    v_mfma_f32_16x16x32_bf16 v[72:75], a[112:115], v[240:243], v[72:75]
    ds_read_b128 a[72:75], v12 offset:59392
    ds_read_b64_tr_b16 a[166:167], v5 offset:6400
    buffer_load_dwordx4 v[200:203], v12, s[20:23], s77 offen offset:2048 sc1
    v_mfma_f32_16x16x32_bf16 v[76:79], a[116:119], v[240:243], v[76:79]
    ds_read_b128 a[76:79], v3 offset:18432
    ds_read_b64_tr_b16 a[168:169], v5 offset:5184
    v_mfma_f32_16x16x32_bf16 v[80:83], a[120:123], v[240:243], v[80:83]
    ds_read_b128 a[80:83], v12 offset:11264
    ds_read_b64_tr_b16 a[170:171], v5 offset:6464
    s_waitcnt lgkmcnt(13)
    v_mfma_f32_16x16x32_bf16 v[64:67], a[124:127], v[244:247], v[64:67]
    ds_read_b128 a[84:87], v12 offset:35840
    ds_read_b64_tr_b16 a[172:173], v6 offset:5248
    ds_read_b64_tr_b16 a[174:175], v6 offset:6528
    v_mfma_f32_16x16x32_bf16 v[68:71], a[128:131], v[244:247], v[68:71]
    ds_read_b128 a[88:91], v12 offset:60416
    ds_read_b64_tr_b16 a[176:177], v5 offset:15392
    buffer_load_dwordx4 v[204:207], v12, s[20:23], s77 offen offset:3072 sc1
    v_mfma_f32_16x16x32_bf16 v[72:75], a[132:135], v[244:247], v[72:75]
    ds_read_b128 a[92:95], v3 offset:19456
    ds_read_b64_tr_b16 a[178:179], v5 offset:16672
    v_mfma_f32_16x16x32_bf16 v[76:79], a[136:139], v[244:247], v[76:79]
    ds_read_b128 a[96:99], v12 offset:12288
    ds_read_b64_tr_b16 a[180:181], v5 offset:15456
    v_mfma_f32_16x16x32_bf16 v[80:83], a[140:143], v[244:247], v[80:83]
    ds_read_b128 a[100:103], v12 offset:36864
    ds_read_b64_tr_b16 a[182:183], v5 offset:16736
    s_waitcnt lgkmcnt(0)
    s_add_u32 s77, s91, 20480
    buffer_load_dwordx4 v[208:211], v12, s[20:23], s77 offen offset:0 sc1
    v_mfma_f32_16x16x32_bf16 v[84:87], a[144:147], v[56:59], 0
    buffer_load_dwordx4 v[212:215], v12, s[20:23], s77 offen offset:1024 sc1
    v_mfma_f32_16x16x32_bf16 v[88:91], a[148:151], v[56:59], 0
    v_mfma_f32_16x16x32_bf16 v[92:95], a[152:155], v[56:59], 0
    v_mul_f32 v128, v28, v64
    v_mul_f32 v129, v28, v65
    v_mul_f32 v130, v28, v66
    v_mfma_f32_16x16x32_bf16 v[96:99], a[156:159], v[56:59], 0
    v_mul_f32 v131, v28, v67
    v_mul_f32 v132, v28, v68
    v_mul_f32 v133, v28, v69
    v_mfma_f32_16x16x32_bf16 v[100:103], a[160:163], v[56:59], 0
    v_mul_f32 v134, v28, v70
    v_mul_f32 v135, v28, v71
    v_mul_f32 v136, v28, v72
    v_mfma_f32_16x16x32_bf16 v[84:87], a[164:167], v[60:63], v[84:87]
    v_mul_f32 v137, v28, v73
    v_mul_f32 v138, v28, v74
    v_mul_f32 v139, v28, v75
    v_mfma_f32_16x16x32_bf16 v[88:91], a[168:171], v[60:63], v[88:91]
    v_mul_f32 v140, v28, v76
    v_mul_f32 v141, v28, v77
    v_mfma_f32_16x16x32_bf16 v[92:95], a[172:175], v[60:63], v[92:95]
    v_mul_f32 v142, v28, v78
    v_mul_f32 v143, v28, v79
    buffer_load_dwordx4 v[216:219], v12, s[20:23], s77 offen offset:2048 sc1
    v_mfma_f32_16x16x32_bf16 v[96:99], a[176:179], v[60:63], v[96:99]
    v_mul_f32 v144, v28, v80
    v_mul_f32 v145, v28, v81
    v_mfma_f32_16x16x32_bf16 v[100:103], a[180:183], v[60:63], v[100:103]
    buffer_load_dwordx4 v[220:223], v12, s[20:23], s77 offen offset:3072 sc1
    v_mul_f32 v146, v28, v82
    v_mul_f32 v147, v28, v83
L_again_11:
    s_waitcnt vmcnt(7)
    v_mfma_f32_16x16x32_bf16 v[104:107], a[64:67], v[192:195], 0
    ds_read_b128 a[104:107], v12 offset:61440
    v_fma_f32 v160, v29, v84, v128
    v_mfma_f32_16x16x32_bf16 v[108:111], a[68:71], v[192:195], 0
    ds_read_b128 a[108:111], v3 offset:20480
    v_fma_f32 v161, v29, v85, v129
    v_mfma_f32_16x16x32_bf16 v[112:115], a[72:75], v[192:195], 0
    ds_read_b128 a[112:115], v12 offset:13312
    v_fma_f32 v162, v29, v86, v130
    v_mfma_f32_16x16x32_bf16 v[116:119], a[76:79], v[192:195], 0
    ds_read_b128 a[116:119], v12 offset:37888
    v_max3_u32 v40, v192, v193, v194
    v_mfma_f32_16x16x32_bf16 v[120:123], a[80:83], v[192:195], 0
    ds_read_b128 a[120:123], v12 offset:62464
    v_max_u32 v40, v40, v195
    s_waitcnt vmcnt(6)
    v_mfma_f32_16x16x32_bf16 v[104:107], a[84:87], v[196:199], v[104:107]
    ds_read_b128 a[124:127], v3 offset:21504
    v_fma_f32 v163, v29, v87, v131
    v_mfma_f32_16x16x32_bf16 v[108:111], a[88:91], v[196:199], v[108:111]
    ds_read_b128 a[128:131], v12 offset:14336
    v_fma_f32 v164, v29, v88, v132
    v_mfma_f32_16x16x32_bf16 v[112:115], a[92:95], v[196:199], v[112:115]
    ds_read_b128 a[132:135], v12 offset:38912
    v_fma_f32 v165, v29, v89, v133
    v_mfma_f32_16x16x32_bf16 v[116:119], a[96:99], v[196:199], v[116:119]
    ds_read_b128 a[136:139], v12 offset:63488
    v_max3_u32 v40, v40, v196, v197
    v_mfma_f32_16x16x32_bf16 v[120:123], a[100:103], v[196:199], v[120:123]
    ds_read_b128 a[140:143], v3 offset:22528
    v_max3_u32 v40, v40, v198, v199
    s_waitcnt lgkmcnt(5)
    s_waitcnt vmcnt(5)
    v_mfma_f32_16x16x32_bf16 v[104:107], a[104:107], v[200:203], v[104:107]
    ds_read_b128 a[64:67], v12 offset:15360
    v_fma_f32 v166, v29, v90, v134
    v_mfma_f32_16x16x32_bf16 v[108:111], a[108:111], v[200:203], v[108:111]
    ds_read_b128 a[68:71], v12 offset:39936
    v_fma_f32 v167, v29, v91, v135
    v_mfma_f32_16x16x32_bf16 v[112:115], a[112:115], v[200:203], v[112:115]
    ds_read_b128 a[72:75], v12 offset:64512
    v_fma_f32 v168, v29, v92, v136
    v_mfma_f32_16x16x32_bf16 v[116:119], a[116:119], v[200:203], v[116:119]
    ds_read_b128 a[76:79], v3 offset:23552
    v_max3_u32 v40, v40, v200, v201
    v_mfma_f32_16x16x32_bf16 v[120:123], a[120:123], v[200:203], v[120:123]
    ds_read_b128 a[80:83], v12 offset:16384
    v_max3_u32 v40, v40, v202, v203
    s_waitcnt lgkmcnt(5)
    s_waitcnt vmcnt(4)
    v_mfma_f32_16x16x32_bf16 v[104:107], a[124:127], v[204:207], v[104:107]
    ds_read_b128 a[84:87], v12 offset:40960
    v_fma_f32 v169, v29, v93, v137
    v_mfma_f32_16x16x32_bf16 v[108:111], a[128:131], v[204:207], v[108:111]
    ds_read_b128 a[88:91], v3 offset:0
    v_fma_f32 v170, v29, v94, v138
    v_mfma_f32_16x16x32_bf16 v[112:115], a[132:135], v[204:207], v[112:115]
    ds_read_b128 a[92:95], v3 offset:24576
    v_fma_f32 v171, v29, v95, v139
    v_mfma_f32_16x16x32_bf16 v[116:119], a[136:139], v[204:207], v[116:119]
    ds_read_b128 a[96:99], v12 offset:17408
    v_max3_u32 v40, v40, v204, v205
    v_mfma_f32_16x16x32_bf16 v[120:123], a[140:143], v[204:207], v[120:123]
    ds_read_b128 a[100:103], v12 offset:41984
    v_max3_u32 v40, v40, v206, v207
    v_cmp_eq_u32 vcc, -1, v40
    s_nop 0
    s_cbranch_vccnz L_retry_12
    s_waitcnt lgkmcnt(5)
    s_waitcnt vmcnt(3)
    v_mfma_f32_16x16x32_bf16 v[104:107], a[64:67], v[208:211], v[104:107]
    ds_read_b128 a[104:107], v3 offset:1024
    v_fma_f32 v172, v29, v96, v140
    v_mfma_f32_16x16x32_bf16 v[108:111], a[68:71], v[208:211], v[108:111]
    ds_read_b128 a[108:111], v3 offset:25600
    v_fma_f32 v173, v29, v97, v141
    v_mfma_f32_16x16x32_bf16 v[112:115], a[72:75], v[208:211], v[112:115]
    ds_read_b128 a[112:115], v12 offset:18432
    v_fma_f32 v174, v29, v98, v142
    v_mfma_f32_16x16x32_bf16 v[116:119], a[76:79], v[208:211], v[116:119]
    ds_read_b128 a[116:119], v12 offset:43008
    v_max3_u32 v40, v40, v208, v209
    v_mfma_f32_16x16x32_bf16 v[120:123], a[80:83], v[208:211], v[120:123]
    ds_read_b128 a[120:123], v3 offset:2048
    v_max3_u32 v40, v40, v210, v211
    s_waitcnt lgkmcnt(5)
    s_waitcnt vmcnt(2)
    v_mfma_f32_16x16x32_bf16 v[104:107], a[84:87], v[212:215], v[104:107]
    ds_read_b128 a[124:127], v3 offset:26624
    v_fma_f32 v175, v29, v99, v143
    v_mfma_f32_16x16x32_bf16 v[108:111], a[88:91], v[212:215], v[108:111]
    ds_read_b128 a[128:131], v12 offset:19456
    v_fma_f32 v176, v29, v100, v144
    v_mfma_f32_16x16x32_bf16 v[112:115], a[92:95], v[212:215], v[112:115]
    ds_read_b128 a[132:135], v12 offset:44032
    v_fma_f32 v177, v29, v101, v145
    v_mfma_f32_16x16x32_bf16 v[116:119], a[96:99], v[212:215], v[116:119]
    ds_read_b128 a[136:139], v3 offset:3072
    v_max3_u32 v40, v40, v212, v213
    v_mfma_f32_16x16x32_bf16 v[120:123], a[100:103], v[212:215], v[120:123]
    ds_read_b128 a[140:143], v3 offset:27648
    v_max3_u32 v40, v40, v214, v215
    s_waitcnt lgkmcnt(5)
    s_waitcnt vmcnt(1)
    v_mfma_f32_16x16x32_bf16 v[104:107], a[104:107], v[216:219], v[104:107]
    v_fma_f32 v178, v29, v102, v146
    v_fma_f32 v179, v29, v103, v147
    v_mfma_f32_16x16x32_bf16 v[108:111], a[108:111], v[216:219], v[108:111]
    v_max3_u32 v40, v40, v216, v217
    v_max3_u32 v40, v40, v218, v219
    v_mfma_f32_16x16x32_bf16 v[112:115], a[112:115], v[216:219], v[112:115]
    v_mfma_f32_16x16x32_bf16 v[116:119], a[116:119], v[216:219], v[116:119]
    v_mfma_f32_16x16x32_bf16 v[120:123], a[120:123], v[216:219], v[120:123]
    s_waitcnt lgkmcnt(0)
    s_waitcnt vmcnt(0)
    v_mfma_f32_16x16x32_bf16 v[104:107], a[124:127], v[220:223], v[104:107]
    v_max3_u32 v40, v40, v220, v221
    v_max3_u32 v40, v40, v222, v223
    v_mfma_f32_16x16x32_bf16 v[108:111], a[128:131], v[220:223], v[108:111]
    v_mfma_f32_16x16x32_bf16 v[112:115], a[132:135], v[220:223], v[112:115]
    v_mfma_f32_16x16x32_bf16 v[116:119], a[136:139], v[220:223], v[116:119]
    v_mfma_f32_16x16x32_bf16 v[120:123], a[140:143], v[220:223], v[120:123]
    v_cmp_eq_u32 vcc, -1, v40
    s_nop 0
    s_cbranch_vccz L_done_13
L_retry_12:
    s_waitcnt vmcnt(0) lgkmcnt(0)
    s_nop 7
    s_cmp_eq_u32 s69, 0
    s_cbranch_scc1 L_done_13
    s_sub_u32 s69, s69, 1
    s_add_u32 s79, s91, 16384
    buffer_load_dwordx4 v[192:195], v12, s[20:23], s79 offen offset:0 sc1
    buffer_load_dwordx4 v[196:199], v12, s[20:23], s79 offen offset:1024 sc1
    buffer_load_dwordx4 v[200:203], v12, s[20:23], s79 offen offset:2048 sc1
    buffer_load_dwordx4 v[204:207], v12, s[20:23], s79 offen offset:3072 sc1
    s_add_u32 s79, s91, 20480
    buffer_load_dwordx4 v[208:211], v12, s[20:23], s79 offen offset:0 sc1
    buffer_load_dwordx4 v[212:215], v12, s[20:23], s79 offen offset:1024 sc1
    buffer_load_dwordx4 v[216:219], v12, s[20:23], s79 offen offset:2048 sc1
    buffer_load_dwordx4 v[220:223], v12, s[20:23], s79 offen offset:3072 sc1
    s_waitcnt vmcnt(0)
    v_max3_u32 v40, v192, v193, v194
    v_max_u32 v40, v40, v195
    v_max3_u32 v40, v40, v196, v197
    v_max3_u32 v40, v40, v198, v199
    v_max3_u32 v40, v40, v200, v201
    v_max3_u32 v40, v40, v202, v203
    v_max3_u32 v40, v40, v204, v205
    v_max3_u32 v40, v40, v206, v207
    v_max3_u32 v40, v40, v208, v209
    v_max3_u32 v40, v40, v210, v211
    v_max3_u32 v40, v40, v212, v213
    v_max3_u32 v40, v40, v214, v215
    v_max3_u32 v40, v40, v216, v217
    v_max3_u32 v40, v40, v218, v219
    v_max3_u32 v40, v40, v220, v221
    v_max3_u32 v40, v40, v222, v223
    v_cmp_eq_u32 vcc, -1, v40
    s_nop 0
    s_cbranch_vccnz L_retry_12
    ds_read_b128 a[64:67], v12 offset:10240
    ds_read_b128 a[68:71], v12 offset:34816
    ds_read_b128 a[72:75], v12 offset:59392
    ds_read_b128 a[76:79], v3 offset:18432
    ds_read_b128 a[80:83], v12 offset:11264
    ds_read_b128 a[84:87], v12 offset:35840
    ds_read_b128 a[88:91], v12 offset:60416
    ds_read_b128 a[92:95], v3 offset:19456
    ds_read_b128 a[96:99], v12 offset:12288
    ds_read_b128 a[100:103], v12 offset:36864
    s_waitcnt lgkmcnt(0)
    s_branch L_again_11
L_done_13:
    s_nop 5
    v_pk_fma_f32 v[64:65], v[104:105], v[28:29], v[160:161] op_sel_hi:[1,0,1]
    v_pk_fma_f32 v[66:67], v[106:107], v[28:29], v[162:163] op_sel_hi:[1,0,1]
    v_cvt_pk_bf16_f32 v128, v64, v65
    v_cvt_pk_bf16_f32 v129, v66, v67
    ds_write_b64 v21, v[128:129] offset:0
    v_pk_fma_f32 v[68:69], v[108:109], v[28:29], v[164:165] op_sel_hi:[1,0,1]
    v_pk_fma_f32 v[70:71], v[110:111], v[28:29], v[166:167] op_sel_hi:[1,0,1]
    v_cvt_pk_bf16_f32 v130, v68, v69
    v_cvt_pk_bf16_f32 v131, v70, v71
    ds_write_b64 v21, v[130:131] offset:32
    v_pk_fma_f32 v[72:73], v[112:113], v[28:29], v[168:169] op_sel_hi:[1,0,1]
    v_pk_fma_f32 v[74:75], v[114:115], v[28:29], v[170:171] op_sel_hi:[1,0,1]
    v_cvt_pk_bf16_f32 v132, v72, v73
    v_cvt_pk_bf16_f32 v133, v74, v75
    ds_write_b64 v21, v[132:133] offset:64
    v_pk_fma_f32 v[76:77], v[116:117], v[28:29], v[172:173] op_sel_hi:[1,0,1]
    v_pk_fma_f32 v[78:79], v[118:119], v[28:29], v[174:175] op_sel_hi:[1,0,1]
    v_cvt_pk_bf16_f32 v134, v76, v77
    v_cvt_pk_bf16_f32 v135, v78, v79
    ds_write_b64 v21, v[134:135] offset:96
    v_pk_fma_f32 v[80:81], v[120:121], v[28:29], v[176:177] op_sel_hi:[1,0,1]
    v_pk_fma_f32 v[82:83], v[122:123], v[28:29], v[178:179] op_sel_hi:[1,0,1]
    v_cvt_pk_bf16_f32 v136, v80, v81
    v_cvt_pk_bf16_f32 v137, v82, v83
    ds_write_b64 v21, v[136:137] offset:128
    s_waitcnt lgkmcnt(0)
    ds_read_b128 v[160:163], v22 offset:0
    ds_read_b128 v[164:167], v22 offset:1024
    ds_read_b128 v[168:171], v22 offset:2048
    s_waitcnt lgkmcnt(2)
    buffer_store_dwordx4 v[160:163], v7, s[24:27], s96 offen offset:0
    s_waitcnt lgkmcnt(1)
    buffer_store_dwordx4 v[164:167], v8, s[24:27], s96 offen offset:1024
    s_mov_b32 exec_hi, 0
    s_waitcnt lgkmcnt(0)
    buffer_store_dwordx4 v[168:171], v9, s[24:27], s96 offen offset:2048
    s_mov_b64 exec, -1
    s_or_b32 s78, s65, s66
    s_or_b32 s78, s78, s64
    s_cmp_eq_u32 s78, 0
    s_cbranch_scc0 L_ep_14
    v_mov_b32 v0, 0
    s_mov_b64 exec, 1
    buffer_store_dword v31, v0, s[20:23], 0 offen sc1
    s_mov_b64 exec, -1
L_ep_14:
L_end:
    s_endpgm
L_code_end:
.set CODE_BYTES, L_code_end - L_pc

.section .rodata,"a"
.p2align 6
.amdhsa_kernel gated_mix__spectral_fnet__mixer_gmlp__prompt_kernel
  .amdhsa_next_free_vgpr 512
  .amdhsa_next_free_sgpr 102
  .amdhsa_accum_offset 256
  .amdhsa_group_segment_fixed_size 0
  .amdhsa_kernarg_size 112
  .amdhsa_user_sgpr_count 2
  .amdhsa_user_sgpr_kernarg_segment_ptr 1
  .amdhsa_system_sgpr_workgroup_id_x 1
  .amdhsa_float_denorm_mode_32 3
.end_amdhsa_kernel
```
